```python
import torch

def _softmax(x, axis=-1):
    return torch.softmax(x, dim=axis)
def _gelu(x):
    return torch.nn.functional.gelu(x, approximate="tanh")
def _silu(x):
    return torch.nn.functional.silu(x)
def _sigmoid(x):
    return torch.sigmoid(x)
def _layernorm(x, axis=-1, eps=1e-5):
    m = x.mean(dim=axis, keepdim=True)
    v = x.var(dim=axis, keepdim=True, unbiased=False)
    return (x - m) / torch.sqrt(v + eps)
def _scatter_add(tgt, idx, src, axis=0):
    return tgt.clone().index_add_(axis, idx, src)
def _segment_sum(src, seg, n):
    out = torch.zeros((n,) + src.shape[1:], dtype=src.dtype)
    return out.index_add_(0, seg, src)
def _pad(x, pw):
    flat = tuple(v for pair in reversed(pw) for v in pair)
    return torch.nn.functional.pad(x, flat)

kernel_name = 'sequential_preLN__spectral_gfnet__dense_activation_mish__prompt'

def setup_inputs():

    _w = (lambda a: (lambda t: t.to(torch.bfloat16) if t.is_floating_point() else t)(torch.as_tensor(a)))
    def _A_setup():
        B, S, D = 1, 2048, 512
        Df = D // 2 + 1
        return {
            "x": _w((lambda *s: torch.randn(*s, dtype=torch.bfloat16) * 0.05)(B, S, D)),
            "w_r": _w((lambda *s: torch.randn(*s, dtype=torch.bfloat16) * 0.4)(S, Df) * 0.02),
            "w_i": _w((lambda *s: torch.randn(*s, dtype=torch.bfloat16) * 0.4)(S, Df) * 0.02),
        }
    _A_in = _A_setup()

    def _B_setup():
        B, S, D, F = 1, 2048, 512, 1792
        return {
            "x": _w((lambda *s: torch.randn(*s, dtype=torch.bfloat16) * 0.05)(B, S, D)),
            "w1": _w((lambda *s: torch.randn(*s, dtype=torch.bfloat16) * 0.8)(D, F) * (D ** -0.5)),
            "b1": _w((lambda *s: torch.randn(*s, dtype=torch.bfloat16) * 0.2)(F)),
            "w2": _w((lambda *s: torch.randn(*s, dtype=torch.bfloat16) * 0.1)(F, D) * (F ** -0.5)),
        }
    _B_in = _B_setup()

    return {
        "A_x": _A_in["x"],
        "A_w_r": _A_in["w_r"],
        "A_w_i": _A_in["w_i"],
        "B_x": _B_in["x"],
        "B_w1": _B_in["w1"],
        "B_b1": _B_in["b1"],
        "B_w2": _B_in["w2"],
    }

def reference(A_x, A_w_r, A_w_i, B_x, B_w1, B_b1, B_w2):
    def _A_ref(x, w_r, w_i):
        B, S, D = x.shape
        X = (lambda x, axes=(-2,-1): torch.fft.rfft2(x.float(), dim=axes))(x, axes=(-2, -1))
        W = w_r + 1j * w_i
        X = X * W
        y = (lambda x, s, axes=(-2,-1): torch.fft.irfft2(x, s=s, dim=axes).to(torch.bfloat16))(X, (S, D), axes=(-2, -1))
        return y

    def _B_ref(x, w1, b1, w2):
        h = torch.einsum("bsd,df->bsf", x, w1) + b1
        sp = torch.log1p(torch.exp(-torch.abs(h))) + torch.where(h > 0, h, torch.zeros_like(h))
        act = h * torch.tanh(sp)
        return torch.einsum("bsf,fd->bsd", act, w2)

    x = A_x
    h = x + _A_ref(_layernorm(x, axis=-1), A_w_r, A_w_i)
    h2 = h + _B_ref(_layernorm(h, axis=-1), B_w1, B_b1, B_w2)
    return h2
```

```asm
; @launch kernel=kA_kernel grid=(256,1,1) block=(256,1,1) lds=40960
; @launch kernel=kB_kernel grid=(256,1,1) block=(256,1,1) lds=163840
.amdgcn_target "amdgcn-amd-amdhsa--gfx950"
.text
.globl kA_kernel
.p2align 8
.type kA_kernel,@function
kA_kernel:

    s_cmp_ge_u32 s2, 256
    s_cbranch_scc1 L_kA_kernel_end
    s_load_dwordx4 s[4:7], s[0:1], 0
    s_load_dwordx2 s[8:9], s[0:1], 16
    s_load_dwordx2 s[10:11], s[0:1], 32
    s_load_dwordx2 s[12:13], s[0:1], 48
    s_load_dwordx2 s[14:15], s[0:1], 72
    v_and_b32 v1, 63, v0
    v_lshrrev_b32 v4, 6, v0
    v_and_b32 v2, 15, v0
    v_readfirstlane_b32 s16, v4
    v_bfe_u32 v3, v0, 4, 2
    s_lshr_b32 s17, s2, 5
    s_lshl_b32 s17, s17, 3
    s_and_b32 s18, s2, 7
    s_add_u32 s17, s17, s18
    s_lshr_b32 s19, s17, 2
    s_and_b32 s17, s17, 3
    s_lshl_b32 s17, s17, 2
    s_lshr_b32 s18, s2, 3
    s_and_b32 s18, s18, 3
    s_add_u32 s17, s17, s18
    s_and_b32 s20, s16, 1
    s_lshr_b32 s21, s16, 1
    s_lshl_b32 s17, s17, 1
    s_add_u32 s17, s17, s20
    s_lshl_b32 s22, s19, 7
    s_add_u32 s22, s22, s17
    s_lshl_b32 s22, s22, 10
    s_lshl_b32 s23, s19, 5
    s_add_u32 s23, s23, s17
    s_lshl_b32 s23, s23, 4
    s_lshl_b32 s24, s16, 12
    v_lshlrev_b32 v7, 4, v1
    s_getpc_b64 s[66:67]
L_pfa_here:
    v_lshlrev_b32 v8, 7, v0
    v_min_u32 v8, L_code_end - L_pfa_here - 4, v8
    v_mov_b32 v9, s67
    v_add_co_u32 v8, vcc, s66, v8
    s_nop 1
    v_addc_co_u32 v9, vcc, 0, v9, vcc
    global_load_dword v10, v[8:9], off
    s_lshl_b32 s26, s2, 2
    s_add_u32 s26, s26, s16
    s_lshr_b32 s27, s26, 3
    s_and_b32 s52, s26, 7
    v_lshrrev_b32 v4, 3, v1
    v_bfe_u32 v5, v1, 4, 1
    v_lshlrev_b32 v5, 2, v5
    v_and_b32 v6, 7, v1
    v_xor_b32 v5, v5, v6
    v_lshlrev_b32 v5, 4, v5
    v_lshl_add_u32 v11, v4, 10, v5
    s_movk_i32 s53, 3584
    v_mul_lo_u32 v12, v4, s53
    v_add_u32 v12, v12, v5
    s_lshl_b32 s53, s27, 14
    s_lshl_b32 s54, s52, 7
    s_add_u32 s53, s53, s54
    s_mul_i32 s55, s26, 2341
    s_lshr_b32 s55, s55, 16
    s_mul_i32 s56, s55, 28
    s_sub_u32 s56, s26, s56
    s_lshr_b32 s57, s55, 1
    s_lshl_b32 s57, s57, 5
    s_and_b32 s58, s55, 1
    s_lshl_b32 s58, s58, 3
    s_add_u32 s57, s57, s58
    s_mul_i32 s57, s57, 3584
    s_lshl_b32 s58, s56, 7
    s_add_u32 s57, s57, s58
    s_lshl_b32 s54, s16, 12
    s_add_u32 s54, s54, 16384
    s_lshr_b32 s60, s2, 3
    s_and_b32 s60, s60, 3
    s_and_b32 s61, s2, 7
    s_lshr_b32 s62, s2, 5
    v_lshrrev_b32 v4, 4, v1
    v_bfe_u32 v5, v1, 2, 2
    v_lshl_add_u32 v4, v5, 6, v4
    s_lshl_b32 s63, s60, 4
    s_lshl_b32 s64, s16, 2
    s_add_u32 s63, s63, s64
    s_lshl_b32 s64, s61, 8
    s_add_u32 s63, s63, s64
    v_add_u32 v4, s63, v4
    s_movk_i32 s64, 514
    v_mul_lo_u32 v15, v4, s64
    v_and_b32 v5, 3, v1
    v_lshl_add_u32 v15, v5, 4, v15
    s_lshl_b32 s63, s62, 6
    s_add_u32 s63, s63, 2
    s_lshl_b32 s65, s16, 11
    s_add_u32 s65, s65, 32768
    s_waitcnt lgkmcnt(0)
    s_mov_b32 s28, s4
    s_mov_b32 s29, s5
    s_mov_b32 s30, 2097152
    s_mov_b32 s31, 0x00020000
    s_add_u32 m0, s24, 0
    s_add_u32 s25, s22, 0
    buffer_load_dwordx4 v7, s[28:31], s25 offen nt lds
    s_add_u32 m0, s24, 1024
    s_add_u32 s25, s22, 32768
    buffer_load_dwordx4 v7, s[28:31], s25 offen nt lds
    s_add_u32 m0, s24, 2048
    s_add_u32 s25, s22, 65536
    buffer_load_dwordx4 v7, s[28:31], s25 offen nt lds
    s_add_u32 m0, s24, 3072
    s_add_u32 s25, s22, 98304
    buffer_load_dwordx4 v7, s[28:31], s25 offen nt lds
    s_mov_b32 s32, s6
    s_mov_b32 s33, s7
    s_mov_b32 s34, 1052672
    s_mov_b32 s35, 0x00020000
    s_mov_b32 s36, s8
    s_mov_b32 s37, s9
    s_mov_b32 s38, 1052672
    s_mov_b32 s39, 0x00020000
    s_mov_b32 s40, s14
    s_mov_b32 s41, s15
    s_mov_b32 s42, 22339584
    s_mov_b32 s43, 0x00020000
    s_mov_b32 s44, s10
    s_mov_b32 s45, s11
    s_mov_b32 s46, 1835008
    s_mov_b32 s47, 0x00020000
    s_mov_b32 s48, s12
    s_mov_b32 s49, s13
    s_mov_b32 s50, 1835008
    s_mov_b32 s51, 0x00020000
    s_lshl_b32 s26, s21, 4
    s_mov_b32 m0, s65
    s_mov_b32 s25, s63
    buffer_load_dwordx4 v15, s[32:35], s25 offen nt lds
    v_add_u32 v4, s26, v2
    s_add_u32 m0, s65, 1024
    s_nop 0
    buffer_load_dwordx4 v15, s[36:39], s25 offen nt lds
    v_cvt_f32_u32 v18, v4
    s_mul_i32 s25, s2, 7168
    s_lshl_b32 s59, s16, 11
    s_add_u32 s25, s25, s59
    buffer_load_dwordx4 v[72:75], v7, s[44:47], s25 offen
    v_lshlrev_b32 v5, 2, v3
    buffer_load_dwordx4 v[76:79], v7, s[44:47], s25 offen offset:1024
    v_cvt_f32_u32 v19, v5
    v_and_b32 v5, 1, v4
    v_mov_b32 v20, 0x80008000
    v_mul_lo_u32 v20, v20, v5
    v_mov_b32 v52, v19
    v_add_f32 v53, 1.0, v19
    v_add_f32 v54, 2.0, v19
    v_add_f32 v55, 3.0, v19
    v_mul_f32 v56, v18, v52
    v_mul_f32 v57, v18, v53
    v_mul_f32 v58, v18, v54
    v_mul_f32 v59, v18, v55
    v_mul_f32 v44, 0x3b000000, v56
    v_mul_f32 v45, 0x3b000000, v57
    v_mul_f32 v46, 0x3b000000, v58
    v_mul_f32 v47, 0x3b000000, v59
    v_cos_f32 v36, v44
    v_sin_f32 v40, v44
    v_cos_f32 v37, v45
    v_sin_f32 v41, v45
    v_cos_f32 v38, v46
    v_sin_f32 v42, v46
    v_cos_f32 v39, v47
    v_sin_f32 v43, v47
    v_mul_f32 v56, 0x3d000000, v56
    v_mul_f32 v57, 0x3d000000, v57
    v_mul_f32 v58, 0x3d000000, v58
    v_mul_f32 v59, 0x3d000000, v59
    v_cos_f32 v44, v56
    v_sin_f32 v48, v56
    v_cos_f32 v45, v57
    v_sin_f32 v49, v57
    v_cos_f32 v46, v58
    v_sin_f32 v50, v58
    v_cos_f32 v47, v59
    v_sin_f32 v51, v59
    v_cvt_pk_bf16_f32 v24, v44, v45
    v_cvt_pk_bf16_f32 v25, v46, v47
    v_cvt_pk_bf16_f32 v28, -v48, -v49
    v_cvt_pk_bf16_f32 v29, -v50, -v51
    v_xor_b32 v26, v20, v24
    v_xor_b32 v27, v20, v25
    v_xor_b32 v30, v20, v28
    v_xor_b32 v31, v20, v29
    v_lshrrev_b32 v4, 1, v2
    v_cvt_f32_u32 v4, v4
    v_and_b32 v5, 1, v2
    v_cvt_f32_u32 v5, v5
    v_mul_f32 v4, 0x3d800000, v4
    v_mul_f32 v5, 0x3e800000, v5
    v_fma_f32 v56, v4, v52, v5
    v_fma_f32 v57, v4, v53, v5
    v_fma_f32 v58, v4, v54, v5
    v_fma_f32 v59, v4, v55, v5
    v_cos_f32 v44, v56
    v_sin_f32 v48, v56
    v_cos_f32 v45, v57
    v_sin_f32 v49, v57
    v_cos_f32 v46, v58
    v_sin_f32 v50, v58
    v_cos_f32 v47, v59
    v_sin_f32 v51, v59
    v_cvt_pk_bf16_f32 v32, v44, v45
    v_cvt_pk_bf16_f32 v33, v46, v47
    v_cvt_pk_bf16_f32 v34, v48, v49
    v_cvt_pk_bf16_f32 v35, v50, v51
    s_lshl_b32 s26, s21, 4
    v_lshl_add_u32 v4, v3, 6, v2
    v_add_u32 v4, s26, v4
    v_add_u32 v5, 31, v4
    v_add_u32 v4, 255, v4
    v_and_b32 v4, 255, v4
    s_mov_b32 s62, 8320
    v_mul_lo_u32 v60, v4, s62
    v_mul_lo_u32 v61, v5, s62
    v_lshlrev_b32 v62, 3, v1
    v_add_u32 v62, s24, v62
    v_mov_b32 v63, 0x3f803f80
    v_and_b32 v4, 1, v1
    v_cvt_f32_u32 v4, v4
    v_fma_f32 v64, v4, -2.0, 1.0
    v_lshrrev_b32 v4, 5, v1
    v_bfe_u32 v5, v1, 2, 2
    v_lshl_add_u32 v4, v4, 2, v5
    v_lshlrev_b32 v13, 7, v4
    v_lshrrev_b32 v5, 1, v5
    v_lshl_add_u32 v13, v5, 6, v13
    v_bfe_u32 v5, v1, 4, 1
    v_lshl_add_u32 v13, v5, 5, v13
    v_and_b32 v5, 3, v1
    v_lshl_add_u32 v13, v5, 3, v13
    v_add_u32 v13, s54, v13
    v_xor_b32 v14, 64, v13
    v_lshlrev_b32 v16, 8, v3
    v_bfe_u32 v4, v1, 2, 2
    v_lshl_add_u32 v16, v4, 6, v16
    v_and_b32 v4, 3, v1
    v_lshl_add_u32 v16, v4, 3, v16
    v_add_u32 v16, s65, v16
    s_lshr_b32 s66, s2, 5
    s_lshl_b32 s66, s66, 5
    v_add_u32 v4, s66, v2
    v_mul_lo_u32 v17, v4, s62
    v_lshl_add_u32 v17, v3, 4, v17
    s_lshl_b32 s66, s60, 1
    s_lshr_b32 s67, s61, 2
    s_add_u32 s66, s66, s67
    s_lshl_b32 s66, s66, 6
    s_and_b32 s67, s61, 3
    s_lshl_b32 s67, s67, 4
    s_add_u32 s66, s66, s67
    s_lshl_b32 s67, s16, 2
    s_add_u32 s66, s66, s67
    s_lshl_b32 s66, s66, 4
    s_add_u32 s66, s66, 2129920
    s_cmp_lt_u32 s2, 2
    s_cbranch_scc0 L_kA_kernel_nz
    v_mov_b32 v80, 0
    v_mov_b32 v81, 0
    v_mov_b32 v82, 0
    v_mov_b32 v83, 0
    s_lshl_b32 s69, s16, 10
    s_lshl_b32 s68, s2, 12
    s_add_u32 s69, s69, s68
    s_add_u32 s69, s69, 22331392
    buffer_store_dwordx4 v[80:83], v7, s[40:43], s69 offen
L_kA_kernel_nz:
    s_waitcnt vmcnt(4)
    ds_read_b64_tr_b16 v[116:117], v62 offset:0
    ds_read_b64_tr_b16 v[118:119], v62 offset:512
    ds_read_b64_tr_b16 v[120:121], v62 offset:1024
    ds_read_b64_tr_b16 v[122:123], v62 offset:1536
    ds_read_b64_tr_b16 v[124:125], v62 offset:2048
    ds_read_b64_tr_b16 v[126:127], v62 offset:2560
    ds_read_b64_tr_b16 v[128:129], v62 offset:3072
    ds_read_b64_tr_b16 v[130:131], v62 offset:3584
    s_waitcnt lgkmcnt(6)
    v_mfma_f32_16x16x32_bf16 v[132:135], v[116:119], v[24:27], 0
    v_mfma_f32_16x16x32_bf16 v[136:139], v[116:119], v[28:31], 0
    s_waitcnt lgkmcnt(4)
    v_mfma_f32_16x16x32_bf16 v[140:143], v[120:123], v[24:27], 0
    v_mfma_f32_16x16x32_bf16 v[144:147], v[120:123], v[28:31], 0
    s_waitcnt lgkmcnt(2)
    v_mfma_f32_16x16x32_bf16 v[148:151], v[124:127], v[24:27], 0
    v_mfma_f32_16x16x32_bf16 v[152:155], v[124:127], v[28:31], 0
    s_waitcnt lgkmcnt(0)
    v_mfma_f32_16x16x32_bf16 v[156:159], v[128:131], v[24:27], 0
    v_mfma_f32_16x16x32_bf16 v[160:163], v[128:131], v[28:31], 0
    v_dot2_f32_bf16 v164, v116, v116, 0
    v_dot2_f32_bf16 v168, v116, v63, 0
    v_dot2_f32_bf16 v165, v120, v120, 0
    v_dot2_f32_bf16 v169, v120, v63, 0
    v_dot2_f32_bf16 v166, v124, v124, 0
    v_dot2_f32_bf16 v170, v124, v63, 0
    v_dot2_f32_bf16 v167, v128, v128, 0
    v_dot2_f32_bf16 v171, v128, v63, 0
    v_dot2_f32_bf16 v164, v117, v117, v164
    v_dot2_f32_bf16 v168, v117, v63, v168
    v_dot2_f32_bf16 v165, v121, v121, v165
    v_dot2_f32_bf16 v169, v121, v63, v169
    v_dot2_f32_bf16 v166, v125, v125, v166
    v_dot2_f32_bf16 v170, v125, v63, v170
    v_dot2_f32_bf16 v167, v129, v129, v167
    v_dot2_f32_bf16 v171, v129, v63, v171
    v_dot2_f32_bf16 v164, v118, v118, v164
    v_dot2_f32_bf16 v168, v118, v63, v168
    v_dot2_f32_bf16 v165, v122, v122, v165
    v_dot2_f32_bf16 v169, v122, v63, v169
    v_dot2_f32_bf16 v166, v126, v126, v166
    v_dot2_f32_bf16 v170, v126, v63, v170
    v_dot2_f32_bf16 v167, v130, v130, v167
    v_dot2_f32_bf16 v171, v130, v63, v171
    v_dot2_f32_bf16 v164, v119, v119, v164
    v_dot2_f32_bf16 v168, v119, v63, v168
    v_dot2_f32_bf16 v165, v123, v123, v165
    v_dot2_f32_bf16 v169, v123, v63, v169
    v_dot2_f32_bf16 v166, v127, v127, v166
    v_dot2_f32_bf16 v170, v127, v63, v170
    v_dot2_f32_bf16 v167, v131, v131, v167
    v_dot2_f32_bf16 v171, v131, v63, v171
    v_mul_f32 v172, v64, v168
    v_mul_f32 v173, v64, v169
    v_mul_f32 v174, v64, v170
    v_mul_f32 v175, v64, v171
    s_waitcnt vmcnt(2)
    ds_read_b64_tr_b16 v[84:85], v16 offset:0
    ds_read_b64_tr_b16 v[88:89], v16 offset:1024
    ds_read_b64_tr_b16 v[86:87], v16 offset:32
    ds_read_b64_tr_b16 v[90:91], v16 offset:1056
    s_mov_b32 s26, 0x05040100
    s_mov_b32 s27, 0x07060302
    s_waitcnt lgkmcnt(0)
    v_perm_b32 v108, v88, v84, s26
    v_perm_b32 v109, v88, v84, s27
    v_perm_b32 v110, v89, v85, s26
    v_perm_b32 v111, v89, v85, s27
    v_perm_b32 v112, v90, v86, s26
    v_perm_b32 v113, v90, v86, s27
    v_perm_b32 v114, v91, v87, s26
    v_perm_b32 v115, v91, v87, s27
    s_add_u32 s67, s66, 133120
    buffer_store_dwordx4 v[108:111], v17, s[40:43], s66 offen
    buffer_store_dwordx4 v[112:115], v17, s[40:43], s67 offen
L_kA_kernel_now2:
    v_add_f32 v164, v164, v164 row_shr:1 row_mask:0xf bank_mask:0xf bound_ctrl:0
    v_add_f32 v165, v165, v165 row_shr:1 row_mask:0xf bank_mask:0xf bound_ctrl:0
    v_add_f32 v166, v166, v166 row_shr:1 row_mask:0xf bank_mask:0xf bound_ctrl:0
    v_add_f32 v167, v167, v167 row_shr:1 row_mask:0xf bank_mask:0xf bound_ctrl:0
    v_add_f32 v168, v168, v168 row_shr:1 row_mask:0xf bank_mask:0xf bound_ctrl:0
    v_add_f32 v169, v169, v169 row_shr:1 row_mask:0xf bank_mask:0xf bound_ctrl:0
    v_add_f32 v170, v170, v170 row_shr:1 row_mask:0xf bank_mask:0xf bound_ctrl:0
    v_add_f32 v171, v171, v171 row_shr:1 row_mask:0xf bank_mask:0xf bound_ctrl:0
    v_add_f32 v172, v172, v172 row_shr:1 row_mask:0xf bank_mask:0xf bound_ctrl:0
    v_add_f32 v173, v173, v173 row_shr:1 row_mask:0xf bank_mask:0xf bound_ctrl:0
    v_add_f32 v174, v174, v174 row_shr:1 row_mask:0xf bank_mask:0xf bound_ctrl:0
    v_add_f32 v175, v175, v175 row_shr:1 row_mask:0xf bank_mask:0xf bound_ctrl:0
    v_add_f32 v164, v164, v164 row_shr:2 row_mask:0xf bank_mask:0xf bound_ctrl:0
    v_add_f32 v165, v165, v165 row_shr:2 row_mask:0xf bank_mask:0xf bound_ctrl:0
    v_add_f32 v166, v166, v166 row_shr:2 row_mask:0xf bank_mask:0xf bound_ctrl:0
    v_add_f32 v167, v167, v167 row_shr:2 row_mask:0xf bank_mask:0xf bound_ctrl:0
    v_add_f32 v168, v168, v168 row_shr:2 row_mask:0xf bank_mask:0xf bound_ctrl:0
    v_add_f32 v169, v169, v169 row_shr:2 row_mask:0xf bank_mask:0xf bound_ctrl:0
    v_add_f32 v170, v170, v170 row_shr:2 row_mask:0xf bank_mask:0xf bound_ctrl:0
    v_add_f32 v171, v171, v171 row_shr:2 row_mask:0xf bank_mask:0xf bound_ctrl:0
    v_add_f32 v172, v172, v172 row_shr:2 row_mask:0xf bank_mask:0xf bound_ctrl:0
    v_add_f32 v173, v173, v173 row_shr:2 row_mask:0xf bank_mask:0xf bound_ctrl:0
    v_add_f32 v174, v174, v174 row_shr:2 row_mask:0xf bank_mask:0xf bound_ctrl:0
    v_add_f32 v175, v175, v175 row_shr:2 row_mask:0xf bank_mask:0xf bound_ctrl:0
    v_add_f32 v164, v164, v164 row_shr:4 row_mask:0xf bank_mask:0xf bound_ctrl:0
    v_add_f32 v165, v165, v165 row_shr:4 row_mask:0xf bank_mask:0xf bound_ctrl:0
    v_add_f32 v166, v166, v166 row_shr:4 row_mask:0xf bank_mask:0xf bound_ctrl:0
    v_add_f32 v167, v167, v167 row_shr:4 row_mask:0xf bank_mask:0xf bound_ctrl:0
    v_add_f32 v168, v168, v168 row_shr:4 row_mask:0xf bank_mask:0xf bound_ctrl:0
    v_add_f32 v169, v169, v169 row_shr:4 row_mask:0xf bank_mask:0xf bound_ctrl:0
    v_add_f32 v170, v170, v170 row_shr:4 row_mask:0xf bank_mask:0xf bound_ctrl:0
    v_add_f32 v171, v171, v171 row_shr:4 row_mask:0xf bank_mask:0xf bound_ctrl:0
    v_add_f32 v172, v172, v172 row_shr:4 row_mask:0xf bank_mask:0xf bound_ctrl:0
    v_add_f32 v173, v173, v173 row_shr:4 row_mask:0xf bank_mask:0xf bound_ctrl:0
    v_add_f32 v174, v174, v174 row_shr:4 row_mask:0xf bank_mask:0xf bound_ctrl:0
    v_add_f32 v175, v175, v175 row_shr:4 row_mask:0xf bank_mask:0xf bound_ctrl:0
    v_add_f32 v164, v164, v164 row_shr:8 row_mask:0xf bank_mask:0xf bound_ctrl:0
    v_add_f32 v165, v165, v165 row_shr:8 row_mask:0xf bank_mask:0xf bound_ctrl:0
    v_add_f32 v166, v166, v166 row_shr:8 row_mask:0xf bank_mask:0xf bound_ctrl:0
    v_add_f32 v167, v167, v167 row_shr:8 row_mask:0xf bank_mask:0xf bound_ctrl:0
    v_add_f32 v168, v168, v168 row_shr:8 row_mask:0xf bank_mask:0xf bound_ctrl:0
    v_add_f32 v169, v169, v169 row_shr:8 row_mask:0xf bank_mask:0xf bound_ctrl:0
    v_add_f32 v170, v170, v170 row_shr:8 row_mask:0xf bank_mask:0xf bound_ctrl:0
    v_add_f32 v171, v171, v171 row_shr:8 row_mask:0xf bank_mask:0xf bound_ctrl:0
    v_add_f32 v172, v172, v172 row_shr:8 row_mask:0xf bank_mask:0xf bound_ctrl:0
    v_add_f32 v173, v173, v173 row_shr:8 row_mask:0xf bank_mask:0xf bound_ctrl:0
    v_add_f32 v174, v174, v174 row_shr:8 row_mask:0xf bank_mask:0xf bound_ctrl:0
    v_add_f32 v175, v175, v175 row_shr:8 row_mask:0xf bank_mask:0xf bound_ctrl:0
    v_add_f32 v164, v164, v164 row_bcast:15 row_mask:0xa bank_mask:0xf
    v_add_f32 v165, v165, v165 row_bcast:15 row_mask:0xa bank_mask:0xf
    v_add_f32 v166, v166, v166 row_bcast:15 row_mask:0xa bank_mask:0xf
    v_add_f32 v167, v167, v167 row_bcast:15 row_mask:0xa bank_mask:0xf
    v_add_f32 v168, v168, v168 row_bcast:15 row_mask:0xa bank_mask:0xf
    v_add_f32 v169, v169, v169 row_bcast:15 row_mask:0xa bank_mask:0xf
    v_add_f32 v170, v170, v170 row_bcast:15 row_mask:0xa bank_mask:0xf
    v_add_f32 v171, v171, v171 row_bcast:15 row_mask:0xa bank_mask:0xf
    v_add_f32 v172, v172, v172 row_bcast:15 row_mask:0xa bank_mask:0xf
    v_add_f32 v173, v173, v173 row_bcast:15 row_mask:0xa bank_mask:0xf
    v_add_f32 v174, v174, v174 row_bcast:15 row_mask:0xa bank_mask:0xf
    v_add_f32 v175, v175, v175 row_bcast:15 row_mask:0xa bank_mask:0xf
    v_add_f32 v164, v164, v164 row_bcast:31 row_mask:0xc bank_mask:0xf
    v_add_f32 v165, v165, v165 row_bcast:31 row_mask:0xc bank_mask:0xf
    v_add_f32 v166, v166, v166 row_bcast:31 row_mask:0xc bank_mask:0xf
    v_add_f32 v167, v167, v167 row_bcast:31 row_mask:0xc bank_mask:0xf
    v_add_f32 v168, v168, v168 row_bcast:31 row_mask:0xc bank_mask:0xf
    v_add_f32 v169, v169, v169 row_bcast:31 row_mask:0xc bank_mask:0xf
    v_add_f32 v170, v170, v170 row_bcast:31 row_mask:0xc bank_mask:0xf
    v_add_f32 v171, v171, v171 row_bcast:31 row_mask:0xc bank_mask:0xf
    v_add_f32 v172, v172, v172 row_bcast:31 row_mask:0xc bank_mask:0xf
    v_add_f32 v173, v173, v173 row_bcast:31 row_mask:0xc bank_mask:0xf
    v_add_f32 v174, v174, v174 row_bcast:31 row_mask:0xc bank_mask:0xf
    v_add_f32 v175, v175, v175 row_bcast:31 row_mask:0xc bank_mask:0xf
    v_pk_mul_f32 v[192:193], v[132:133], v[36:37]
    v_pk_mul_f32 v[196:197], v[136:137], v[36:37]
    v_pk_mul_f32 v[194:195], v[134:135], v[38:39]
    v_pk_mul_f32 v[198:199], v[138:139], v[38:39]
    v_pk_fma_f32 v[192:193], v[136:137], v[40:41], v[192:193]
    v_pk_fma_f32 v[196:197], v[132:133], v[40:41], v[196:197] neg_lo:[1,0,0] neg_hi:[1,0,0]
    v_pk_fma_f32 v[194:195], v[138:139], v[42:43], v[194:195]
    v_pk_fma_f32 v[198:199], v[134:135], v[42:43], v[198:199] neg_lo:[1,0,0] neg_hi:[1,0,0]
    v_cvt_pk_bf16_f32 v176, v192, v193
    v_cvt_pk_bf16_f32 v177, v194, v195
    v_cvt_pk_bf16_f32 v178, v196, v197
    v_cvt_pk_bf16_f32 v179, v198, v199
    s_nop 1
    v_mfma_f32_16x16x32_bf16 v[132:135], v[32:35], v[176:179], 0
    v_pk_mul_f32 v[192:193], v[140:141], v[36:37]
    v_pk_mul_f32 v[196:197], v[144:145], v[36:37]
    v_pk_mul_f32 v[194:195], v[142:143], v[38:39]
    v_pk_mul_f32 v[198:199], v[146:147], v[38:39]
    v_pk_fma_f32 v[192:193], v[144:145], v[40:41], v[192:193]
    v_pk_fma_f32 v[196:197], v[140:141], v[40:41], v[196:197] neg_lo:[1,0,0] neg_hi:[1,0,0]
    v_pk_fma_f32 v[194:195], v[146:147], v[42:43], v[194:195]
    v_pk_fma_f32 v[198:199], v[142:143], v[42:43], v[198:199] neg_lo:[1,0,0] neg_hi:[1,0,0]
    v_cvt_pk_bf16_f32 v180, v192, v193
    v_cvt_pk_bf16_f32 v181, v194, v195
    v_cvt_pk_bf16_f32 v182, v196, v197
    v_cvt_pk_bf16_f32 v183, v198, v199
    s_nop 1
    v_mfma_f32_16x16x32_bf16 v[140:143], v[32:35], v[180:183], 0
    v_pk_mul_f32 v[192:193], v[148:149], v[36:37]
    v_pk_mul_f32 v[196:197], v[152:153], v[36:37]
    v_pk_mul_f32 v[194:195], v[150:151], v[38:39]
    v_pk_mul_f32 v[198:199], v[154:155], v[38:39]
    v_pk_fma_f32 v[192:193], v[152:153], v[40:41], v[192:193]
    v_pk_fma_f32 v[196:197], v[148:149], v[40:41], v[196:197] neg_lo:[1,0,0] neg_hi:[1,0,0]
    v_pk_fma_f32 v[194:195], v[154:155], v[42:43], v[194:195]
    v_pk_fma_f32 v[198:199], v[150:151], v[42:43], v[198:199] neg_lo:[1,0,0] neg_hi:[1,0,0]
    v_cvt_pk_bf16_f32 v184, v192, v193
    v_cvt_pk_bf16_f32 v185, v194, v195
    v_cvt_pk_bf16_f32 v186, v196, v197
    v_cvt_pk_bf16_f32 v187, v198, v199
    s_nop 1
    v_mfma_f32_16x16x32_bf16 v[148:151], v[32:35], v[184:187], 0
    v_pk_mul_f32 v[192:193], v[156:157], v[36:37]
    v_pk_mul_f32 v[196:197], v[160:161], v[36:37]
    v_pk_mul_f32 v[194:195], v[158:159], v[38:39]
    v_pk_mul_f32 v[198:199], v[162:163], v[38:39]
    v_pk_fma_f32 v[192:193], v[160:161], v[40:41], v[192:193]
    v_pk_fma_f32 v[196:197], v[156:157], v[40:41], v[196:197] neg_lo:[1,0,0] neg_hi:[1,0,0]
    v_pk_fma_f32 v[194:195], v[162:163], v[42:43], v[194:195]
    v_pk_fma_f32 v[198:199], v[158:159], v[42:43], v[198:199] neg_lo:[1,0,0] neg_hi:[1,0,0]
    v_cvt_pk_bf16_f32 v188, v192, v193
    v_cvt_pk_bf16_f32 v189, v194, v195
    v_cvt_pk_bf16_f32 v190, v196, v197
    v_cvt_pk_bf16_f32 v191, v198, v199
    s_nop 1
    v_mfma_f32_16x16x32_bf16 v[156:159], v[32:35], v[188:191], 0
    v_mul_f32 v168, 0x3b000000, v168
    v_mul_f32 v169, 0x3b000000, v169
    v_mul_f32 v170, 0x3b000000, v170
    v_mul_f32 v171, 0x3b000000, v171
    v_mul_f32 v168, v168, v168
    v_mul_f32 v169, v169, v169
    v_mul_f32 v170, v170, v170
    v_mul_f32 v171, v171, v171
    s_mov_b32 s26, 0x3b000000
    v_fma_f32 v164, v164, s26, -v168
    v_fma_f32 v165, v165, s26, -v169
    v_fma_f32 v166, v166, s26, -v170
    v_fma_f32 v167, v167, s26, -v171
    v_max_f32 v164, 0, v164
    v_max_f32 v165, 0, v165
    v_max_f32 v166, 0, v166
    v_max_f32 v167, 0, v167
    v_add_f32 v164, 0x3727c5ac, v164
    v_add_f32 v165, 0x3727c5ac, v165
    v_add_f32 v166, 0x3727c5ac, v166
    v_add_f32 v167, 0x3727c5ac, v167
    v_rsq_f32 v164, v164
    v_rsq_f32 v165, v165
    v_rsq_f32 v166, v166
    v_rsq_f32 v167, v167
    v_mul_f32 v164, 0x36000000, v164
    v_mul_f32 v165, 0x36000000, v165
    v_mul_f32 v166, 0x36000000, v166
    v_mul_f32 v167, 0x36000000, v167
    v_mul_f32 v172, v164, v172
    v_mul_f32 v173, v165, v173
    v_mul_f32 v174, v166, v174
    v_mul_f32 v175, v167, v175
    v_mul_f32 v172, 0.5, v172
    v_mul_f32 v173, 0.5, v173
    v_mul_f32 v174, 0.5, v174
    v_mul_f32 v175, 0.5, v175
    v_readlane_b32 s28, v164, 63
    v_readlane_b32 s32, v172, 63
    v_readlane_b32 s29, v165, 63
    v_readlane_b32 s33, v173, 63
    v_readlane_b32 s30, v166, 63
    v_readlane_b32 s34, v174, 63
    v_readlane_b32 s31, v167, 63
    v_readlane_b32 s35, v175, 63
    v_mul_f32 v132, s28, v132
    v_mul_f32 v133, s28, v133
    v_mul_f32 v134, s28, v134
    v_mul_f32 v135, s28, v135
    v_mul_f32 v140, s29, v140
    v_mul_f32 v141, s29, v141
    v_mul_f32 v142, s29, v142
    v_mul_f32 v143, s29, v143
    v_mul_f32 v148, s30, v148
    v_mul_f32 v149, s30, v149
    v_mul_f32 v150, s30, v150
    v_mul_f32 v151, s30, v151
    v_mul_f32 v156, s31, v156
    v_mul_f32 v157, s31, v157
    v_mul_f32 v158, s31, v158
    v_mul_f32 v159, s31, v159
    v_cvt_pk_bf16_f32 v200, v132, v133
    v_cvt_pk_bf16_f32 v204, v134, v135
    v_cvt_pk_bf16_f32 v201, v140, v141
    v_cvt_pk_bf16_f32 v205, v142, v143
    v_cvt_pk_bf16_f32 v202, v148, v149
    v_cvt_pk_bf16_f32 v206, v150, v151
    v_cvt_pk_bf16_f32 v203, v156, v157
    v_cvt_pk_bf16_f32 v207, v158, v159
    s_cmp_eq_u32 s21, 0
    s_cbranch_scc0 L_kA_kernel_nonyq
    v_mov_b32 v4, s32
    v_cvt_pk_bf16_f32 v4, v4, 0
    s_nop 0
    v_readfirstlane_b32 s36, v4
    s_nop 3
    v_writelane_b32 v200, s36, 0
    v_mov_b32 v4, s33
    v_cvt_pk_bf16_f32 v4, v4, 0
    s_nop 0
    v_readfirstlane_b32 s37, v4
    s_nop 3
    v_writelane_b32 v201, s37, 0
    v_mov_b32 v4, s34
    v_cvt_pk_bf16_f32 v4, v4, 0
    s_nop 0
    v_readfirstlane_b32 s38, v4
    s_nop 3
    v_writelane_b32 v202, s38, 0
    v_mov_b32 v4, s35
    v_cvt_pk_bf16_f32 v4, v4, 0
    s_nop 0
    v_readfirstlane_b32 s39, v4
    s_nop 3
    v_writelane_b32 v203, s39, 0
L_kA_kernel_nonyq:
    v_or_b32 v200, 1, v200
    v_or_b32 v204, 1, v204
    v_or_b32 v201, 1, v201
    v_or_b32 v205, 1, v205
    v_or_b32 v202, 1, v202
    v_or_b32 v206, 1, v206
    v_or_b32 v203, 1, v203
    v_or_b32 v207, 1, v207
    s_nop 4
    s_add_u32 s27, s23, 0
    buffer_store_dwordx4 v[200:203], v60, s[40:43], s27 offen
    buffer_store_dwordx4 v[204:207], v61, s[40:43], s27 offen
L_kA_kernel_end:
    s_endpgm
.section .rodata,"a"
.p2align 6
.amdhsa_kernel kA_kernel
  .amdhsa_next_free_vgpr 208
  .amdhsa_next_free_sgpr 102
  .amdhsa_accum_offset 208
  .amdhsa_group_segment_fixed_size 0
  .amdhsa_kernarg_size 80
  .amdhsa_user_sgpr_count 2
  .amdhsa_user_sgpr_kernarg_segment_ptr 1
  .amdhsa_system_sgpr_workgroup_id_x 1
  .amdhsa_float_denorm_mode_32 3
  .amdhsa_float_denorm_mode_16_64 3
.end_amdhsa_kernel
.text

.text
.globl kB_kernel
.p2align 8
.type kB_kernel,@function
kB_kernel:

    s_cmp_ge_u32 s2, 256
    s_cbranch_scc1 L_kB_kernel_end
    s_load_dwordx2 s[4:5], s[0:1], 0
    s_load_dwordx4 s[8:11], s[0:1], 32
    s_load_dwordx2 s[12:13], s[0:1], 56
    s_load_dwordx2 s[14:15], s[0:1], 72
    s_load_dwordx2 s[6:7], s[0:1], 48
    s_getreg_b32 s38, hwreg(HW_REG_XCC_ID, 0, 3)
    s_and_b32 s56, s2, 7
    s_lshr_b32 s57, s2, 3
    v_and_b32 v3, 63, v0
    v_lshrrev_b32 v7, 6, v0
    v_and_b32 v4, 15, v0
    v_readfirstlane_b32 s16, v7
    v_bfe_u32 v5, v0, 4, 2
    v_lshlrev_b32 v6, 4, v3
    s_cmp_ge_u32 s57, 14
    s_cselect_b32 s59, 1, 0
    s_mul_i32 s17, s59, 14
    s_sub_u32 s60, s57, s17
    v_lshrrev_b32 v7, 4, v3
    v_lshlrev_b32 v8, 2, v7
    v_xor_b32 v8, v8, v4
    v_lshlrev_b32 v8, 4, v8
    s_movk_i32 s23, 3584
    v_mul_lo_u32 v10, v7, s23
    v_add_u32 v10, v10, v8
    s_min_u32 s17, s60, 13
    s_lshl_b32 s61, s17, 8
    s_mul_i32 s18, s16, 14336
    s_add_u32 s61, s61, s18
    s_lshl_b32 s68, s16, 10
    s_and_b32 s17, s57, 7
    s_mul_i32 s63, s17, 247808
    s_mul_i32 s18, s16, 30720
    s_add_u32 s63, s63, s18
    s_add_u32 s63, s63, 18513920
    s_and_b32 s17, s16, 1
    s_mul_i32 s18, s17, 123904
    s_xor_b32 s17, s17, 1
    s_mul_i32 s17, s17, 123904
    s_add_u32 s64, s63, s17
    s_add_u32 s63, s63, s18
    s_mul_i32 s17, s2, 8320
    s_lshl_b32 s18, s16, 11
    s_add_u32 s19, s17, s18
    s_waitcnt lgkmcnt(0)
    s_mov_b32 s40, s14
    s_mov_b32 s41, s15
    s_mov_b32 s42, 22339584
    s_mov_b32 s43, 0x00020000
    s_add_u32 s20, s19, 0
    s_add_u32 m0, s18, 131072
    s_nop 0
    buffer_load_dwordx4 v6, s[40:43], s20 offen  lds
    buffer_load_dwordx4 v6, s[40:43], s20 offen offset:1024  lds
    s_add_u32 s21, s19, 2129920
    buffer_load_dwordx4 v[24:27], v6, s[40:43], s21 offen
    buffer_load_dwordx4 v[28:31], v6, s[40:43], s21 offen offset:1024
    s_mov_b32 s32, s6
    s_mov_b32 s33, s7
    s_mov_b32 s34, 1835008
    s_mov_b32 s35, 0x00020000
    s_lshl_b32 s26, s2, 2
    s_add_u32 s26, s26, s16
    s_lshr_b32 s27, s26, 3
    s_and_b32 s36, s26, 7
    v_lshrrev_b32 v7, 3, v3
    v_bfe_u32 v8, v3, 4, 1
    v_lshlrev_b32 v8, 2, v8
    v_and_b32 v9, 7, v3
    v_xor_b32 v8, v8, v9
    v_lshlrev_b32 v8, 4, v8
    v_lshl_add_u32 v11, v7, 10, v8
    s_lshl_b32 s24, s27, 14
    s_lshl_b32 s25, s36, 7
    s_add_u32 s24, s24, s25
    s_lshl_b32 s37, s16, 11
    s_add_u32 s37, s37, 155648
    s_mov_b32 m0, s37
    s_nop 0
    buffer_load_dwordx4 v11, s[32:35], s24 offen nt lds
    s_add_u32 m0, s37, 1024
    s_add_u32 s24, s24, 8192
    buffer_load_dwordx4 v11, s[32:35], s24 offen nt lds
    v_lshrrev_b32 v7, 5, v3
    v_bfe_u32 v8, v3, 2, 2
    v_lshl_add_u32 v7, v7, 2, v8
    v_lshlrev_b32 v12, 7, v7
    v_lshrrev_b32 v8, 1, v8
    v_lshl_add_u32 v12, v8, 6, v12
    v_bfe_u32 v8, v3, 4, 1
    v_lshl_add_u32 v12, v8, 5, v12
    v_and_b32 v8, 3, v3
    v_lshl_add_u32 v12, v8, 3, v12
    v_add_u32 v12, s37, v12
    v_xor_b32 v13, 64, v12
    s_mul_i32 s36, s36, 247808
    s_mul_i32 s37, s27, 2341
    s_lshr_b32 s37, s37, 16
    s_lshl_b32 s37, s37, 11
    s_lshl_b32 s27, s27, 10
    s_add_u32 s36, s36, s27
    s_add_u32 s36, s36, s37
    s_add_u32 s36, s36, 18513920
    s_add_u32 s37, s36, 123904
    s_mov_b32 s39, s26
    s_cmp_eq_u32 s16, 0
    s_cbranch_scc0 L_kB_kernel_notick
    s_lshl_b32 s20, s38, 3
    s_lshl_b64 s[24:25], 1, s20
    s_lshl_b32 s20, s56, 7
    s_add_u32 s20, s20, 22331392
    v_mov_b32 v1, s20
    v_mov_b32 v32, s24
    v_mov_b32 v33, s25
    s_mov_b64 exec, 1
    buffer_atomic_add_x2 v[32:33], v1, s[40:43], 0 offen
    s_mov_b64 exec, -1
L_kB_kernel_notick:
    s_mov_b32 s28, s4
    s_mov_b32 s29, s5
    s_mov_b32 s30, 2097152
    s_mov_b32 s31, 0x00020000
    s_mov_b32 s44, s8
    s_mov_b32 s45, s9
    s_mov_b32 s46, 1835008
    s_mov_b32 s47, 0x00020000
    s_mov_b32 s48, s10
    s_mov_b32 s49, s11
    s_mov_b32 s50, 3584
    s_mov_b32 s51, 0x00020000
    s_mov_b32 s52, s12
    s_mov_b32 s53, s13
    s_mov_b32 s54, 2097152
    s_mov_b32 s55, 0x00020000
    s_lshl_b32 s22, s16, 4
    v_add_u32 v7, s22, v4
    v_cvt_f32_u32 v34, v7
    v_cvt_f32_u32 v36, v4
    v_lshlrev_b32 v8, 2, v5
    v_cvt_f32_u32 v35, v8
    v_and_b32 v8, 1, v4
    v_mov_b32 v37, 0x80008000
    v_mul_lo_u32 v37, v37, v8
    v_mov_b32 v128, v35
    v_add_f32 v129, 1.0, v35
    v_add_f32 v130, 2.0, v35
    v_add_f32 v131, 3.0, v35
    v_mul_f32 v7, 0x3c800000, v34
    v_mul_f32 v8, 0x3e800000, v34
    v_mul_f32 v132, v7, v128
    v_fma_f32 v136, v7, v128, v8
    v_mul_f32 v133, v7, v129
    v_fma_f32 v137, v7, v129, v8
    v_mul_f32 v134, v7, v130
    s_add_u32 m0, s68, 0
    s_add_u32 s62, s61, 0
    buffer_load_dwordx4 v10, s[44:47], s62 offen lds
    v_fma_f32 v138, v7, v130, v8
    v_mul_f32 v135, v7, v131
    v_fma_f32 v139, v7, v131, v8
    v_cos_f32 v140, v132
    v_sin_f32 v148, v132
    v_cos_f32 v141, v133
    v_sin_f32 v149, v133
    v_cos_f32 v142, v134
    v_sin_f32 v150, v134
    v_cos_f32 v143, v135
    v_sin_f32 v151, v135
    v_cos_f32 v144, v136
    v_sin_f32 v152, v136
    v_cos_f32 v145, v137
    v_sin_f32 v153, v137
    v_cos_f32 v146, v138
    v_sin_f32 v154, v138
    v_cos_f32 v147, v139
    v_sin_f32 v155, v139
    v_cvt_pk_bf16_f32 v40, v140, v148
    s_add_u32 m0, s68, 4096
    s_add_u32 s62, s61, 57344
    buffer_load_dwordx4 v10, s[44:47], s62 offen lds
    v_cvt_pk_bf16_f32 v56, -v148, v140
    v_cvt_pk_bf16_f32 v41, v141, v149
    v_cvt_pk_bf16_f32 v57, -v149, v141
    v_cvt_pk_bf16_f32 v42, v142, v150
    v_cvt_pk_bf16_f32 v58, -v150, v142
    v_cvt_pk_bf16_f32 v43, v143, v151
    v_cvt_pk_bf16_f32 v59, -v151, v143
    v_cvt_pk_bf16_f32 v44, v144, v152
    v_cvt_pk_bf16_f32 v60, -v152, v144
    v_cvt_pk_bf16_f32 v45, v145, v153
    v_cvt_pk_bf16_f32 v61, -v153, v145
    v_cvt_pk_bf16_f32 v46, v146, v154
    v_cvt_pk_bf16_f32 v62, -v154, v146
    v_cvt_pk_bf16_f32 v47, v147, v155
    v_cvt_pk_bf16_f32 v63, -v155, v147
    v_xor_b32 v48, v37, v40
    v_xor_b32 v64, v37, v56
    v_xor_b32 v49, v37, v41
    v_xor_b32 v65, v37, v57
    v_xor_b32 v50, v37, v42
    s_add_u32 m0, s68, 8192
    s_add_u32 s62, s61, 114688
    buffer_load_dwordx4 v10, s[44:47], s62 offen lds
    v_xor_b32 v66, v37, v58
    v_xor_b32 v51, v37, v43
    v_xor_b32 v67, v37, v59
    v_xor_b32 v52, v37, v44
    v_xor_b32 v68, v37, v60
    v_xor_b32 v53, v37, v45
    v_xor_b32 v69, v37, v61
    v_xor_b32 v54, v37, v46
    v_xor_b32 v70, v37, v62
    v_xor_b32 v55, v37, v47
    v_xor_b32 v71, v37, v63
    v_mul_f32 v7, 0x3d000000, v36
    v_mul_f32 v132, v7, v128
    v_mul_f32 v133, v7, v129
    v_mul_f32 v134, v7, v130
    v_mul_f32 v135, v7, v131
    v_cos_f32 v140, v132
    v_sin_f32 v148, v132
    v_cos_f32 v141, v133
    v_sin_f32 v149, v133
    s_add_u32 m0, s68, 12288
    s_add_u32 s62, s61, 172032
    buffer_load_dwordx4 v10, s[44:47], s62 offen lds
    v_cos_f32 v142, v134
    v_sin_f32 v150, v134
    v_cos_f32 v143, v135
    v_sin_f32 v151, v135
    v_cvt_pk_bf16_f32 v72, v140, v141
    v_cvt_pk_bf16_f32 v73, v142, v143
    v_cvt_pk_bf16_f32 v80, v148, v149
    v_cvt_pk_bf16_f32 v81, v150, v151
    v_xor_b32 v74, v37, v72
    v_xor_b32 v82, v37, v80
    v_xor_b32 v75, v37, v73
    v_xor_b32 v83, v37, v81
    v_xor_b32 v76, 0x80000000, v72
    v_xor_b32 v84, 0x80000000, v80
    v_xor_b32 v77, 0x80000000, v73
    v_xor_b32 v85, 0x80000000, v81
    v_xor_b32 v78, 0x80000000, v74
    v_xor_b32 v86, 0x80000000, v82
    v_xor_b32 v79, 0x80000000, v75
    v_xor_b32 v87, 0x80000000, v83
    s_add_u32 m0, s68, 16384
    s_add_u32 s62, s61, 229376
    buffer_load_dwordx4 v10, s[44:47], s62 offen lds
    v_xor_b32 v88, 0x80008000, v80
    v_xor_b32 v89, 0x80008000, v81
    v_xor_b32 v90, 0x80008000, v82
    v_xor_b32 v91, 0x80008000, v83
    v_xor_b32 v92, 0x80008000, v84
    v_xor_b32 v93, 0x80008000, v85
    v_xor_b32 v94, 0x80008000, v86
    v_xor_b32 v95, 0x80008000, v87
    v_mul_f32 v7, 0x3a000000, v34
    v_mul_f32 v8, 0x3c000000, v34
    v_mul_f32 v132, v7, v128
    v_fma_f32 v136, v7, v128, v8
    v_mul_f32 v133, v7, v129
    v_fma_f32 v137, v7, v129, v8
    v_mul_f32 v134, v7, v130
    v_fma_f32 v138, v7, v130, v8
    v_mul_f32 v135, v7, v131
    v_fma_f32 v139, v7, v131, v8
    v_cos_f32 v96, v132
    v_sin_f32 v104, v132
    s_add_u32 m0, s68, 20480
    s_add_u32 s62, s61, 286720
    buffer_load_dwordx4 v10, s[44:47], s62 offen lds
    v_cos_f32 v97, v133
    v_sin_f32 v105, v133
    v_cos_f32 v98, v134
    v_sin_f32 v106, v134
    v_cos_f32 v99, v135
    v_sin_f32 v107, v135
    v_cos_f32 v100, v136
    v_sin_f32 v108, v136
    v_cos_f32 v101, v137
    v_sin_f32 v109, v137
    v_cos_f32 v102, v138
    v_sin_f32 v110, v138
    v_cos_f32 v103, v139
    v_sin_f32 v111, v139
    v_cvt_f32_u32 v9, s22
    v_add_f32 v140, v9, v128
    v_add_f32 v141, v9, v129
    v_add_f32 v142, v9, v130
    v_add_f32 v143, v9, v131
    v_mul_f32 v7, 0x3a000000, v36
    s_add_u32 m0, s68, 24576
    s_add_u32 s62, s61, 344064
    buffer_load_dwordx4 v10, s[44:47], s62 offen lds
    v_add_f32 v8, 0x3c000000, v7
    v_mul_f32 v132, v7, v140
    v_mul_f32 v136, v8, v140
    v_mul_f32 v133, v7, v141
    v_mul_f32 v137, v8, v141
    v_mul_f32 v134, v7, v142
    v_mul_f32 v138, v8, v142
    v_mul_f32 v135, v7, v143
    v_mul_f32 v139, v8, v143
    v_cos_f32 v112, v132
    v_sin_f32 v120, v132
    v_cos_f32 v113, v133
    v_sin_f32 v121, v133
    v_cos_f32 v114, v134
    v_sin_f32 v122, v134
    v_cos_f32 v115, v135
    v_sin_f32 v123, v135
    v_cos_f32 v116, v136
    v_sin_f32 v124, v136
    v_cos_f32 v117, v137
    s_add_u32 m0, s68, 28672
    s_add_u32 s62, s61, 401408
    buffer_load_dwordx4 v10, s[44:47], s62 offen lds
    v_sin_f32 v125, v137
    v_cos_f32 v118, v138
    v_sin_f32 v126, v138
    v_cos_f32 v119, v139
    v_sin_f32 v127, v139
    v_lshlrev_b32 v128, 9, v5
    v_lshl_add_u32 v128, v4, 4, v128
    v_add_u32 v128, 131072, v128
    s_waitcnt vmcnt(12)
    s_barrier
    ds_read_b128 v[132:135], v128 offset:0
    ds_read_b128 v[148:151], v128 offset:256
    ds_read_b128 v[136:139], v128 offset:2048
    ds_read_b128 v[152:155], v128 offset:2304
    ds_read_b128 v[140:143], v128 offset:4096
    ds_read_b128 v[156:159], v128 offset:4352
    ds_read_b128 v[144:147], v128 offset:6144
    ds_read_b128 v[160:163], v128 offset:6400
    s_waitcnt lgkmcnt(6)
    v_mfma_f32_16x16x32_bf16 v[164:167], v[132:135], v[40:43], 0
    v_mfma_f32_16x16x32_bf16 v[172:175], v[132:135], v[56:59], 0
    v_mfma_f32_16x16x32_bf16 v[168:171], v[148:151], v[40:43], 0
    v_mfma_f32_16x16x32_bf16 v[176:179], v[148:151], v[56:59], 0
    s_waitcnt lgkmcnt(4)
    v_mfma_f32_16x16x32_bf16 v[164:167], v[136:139], v[44:47], v[164:167]
    v_mfma_f32_16x16x32_bf16 v[172:175], v[136:139], v[60:63], v[172:175]
    v_mfma_f32_16x16x32_bf16 v[168:171], v[152:155], v[44:47], v[168:171]
    v_mfma_f32_16x16x32_bf16 v[176:179], v[152:155], v[60:63], v[176:179]
    s_waitcnt lgkmcnt(2)
    s_waitcnt vmcnt(10)
    v_mfma_f32_16x16x32_bf16 v[164:167], v[140:143], v[48:51], v[164:167]
    v_lshlrev_b32 v180, 16, v24
    v_and_b32 v188, 0xffff0000, v24
    v_mfma_f32_16x16x32_bf16 v[172:175], v[140:143], v[64:67], v[172:175]
    v_lshlrev_b32 v181, 16, v25
    v_and_b32 v189, 0xffff0000, v25
    v_mfma_f32_16x16x32_bf16 v[168:171], v[156:159], v[48:51], v[168:171]
    v_lshlrev_b32 v182, 16, v26
    v_and_b32 v190, 0xffff0000, v26
    v_mfma_f32_16x16x32_bf16 v[176:179], v[156:159], v[64:67], v[176:179]
    v_lshlrev_b32 v183, 16, v27
    v_and_b32 v191, 0xffff0000, v27
    s_waitcnt lgkmcnt(0)
    v_mfma_f32_16x16x32_bf16 v[164:167], v[144:147], v[52:55], v[164:167]
    v_lshlrev_b32 v184, 16, v28
    v_and_b32 v192, 0xffff0000, v28
    v_mfma_f32_16x16x32_bf16 v[172:175], v[144:147], v[68:71], v[172:175]
    v_lshlrev_b32 v185, 16, v29
    v_and_b32 v193, 0xffff0000, v29
    v_mfma_f32_16x16x32_bf16 v[168:171], v[160:163], v[52:55], v[168:171]
    v_lshlrev_b32 v186, 16, v30
    v_and_b32 v194, 0xffff0000, v30
    v_mfma_f32_16x16x32_bf16 v[176:179], v[160:163], v[68:71], v[176:179]
    v_lshlrev_b32 v187, 16, v31
    v_and_b32 v195, 0xffff0000, v31
    v_pk_mul_f32 v[196:197], v[164:165], v[96:97]
    v_pk_mul_f32 v[204:205], v[172:173], v[96:97]
    v_pk_mul_f32 v[198:199], v[166:167], v[98:99]
    v_pk_mul_f32 v[206:207], v[174:175], v[98:99]
    v_pk_mul_f32 v[200:201], v[168:169], v[100:101]
    s_nop 0
    v_pk_mul_f32 v[208:209], v[176:177], v[100:101]
    v_pk_mul_f32 v[202:203], v[170:171], v[102:103]
    v_pk_mul_f32 v[210:211], v[178:179], v[102:103]
    v_pk_fma_f32 v[196:197], v[172:173], v[104:105], v[196:197]
    v_pk_fma_f32 v[204:205], v[164:165], v[104:105], v[204:205] neg_lo:[1,0,0] neg_hi:[1,0,0]
    v_pk_fma_f32 v[198:199], v[174:175], v[106:107], v[198:199]
    v_pk_fma_f32 v[206:207], v[166:167], v[106:107], v[206:207] neg_lo:[1,0,0] neg_hi:[1,0,0]
    v_pk_fma_f32 v[200:201], v[176:177], v[108:109], v[200:201]
    v_pk_fma_f32 v[208:209], v[168:169], v[108:109], v[208:209] neg_lo:[1,0,0] neg_hi:[1,0,0]
    v_pk_fma_f32 v[202:203], v[178:179], v[110:111], v[202:203]
    v_pk_fma_f32 v[210:211], v[170:171], v[110:111], v[210:211] neg_lo:[1,0,0] neg_hi:[1,0,0]
    v_cvt_pk_bf16_f32 v212, v196, v197
    v_cvt_pk_bf16_f32 v213, v198, v199
    v_cvt_pk_bf16_f32 v214, v200, v201
    v_cvt_pk_bf16_f32 v215, v202, v203
    v_cvt_pk_bf16_f32 v216, v204, v205
    v_cvt_pk_bf16_f32 v217, v206, v207
    v_cvt_pk_bf16_f32 v218, v208, v209
    v_cvt_pk_bf16_f32 v219, v210, v211
    v_mfma_f32_16x16x32_bf16 v[164:167], v[72:75], v[212:215], 0
    s_nop 0
    v_mfma_f32_16x16x32_bf16 v[172:175], v[72:75], v[216:219], 0
    v_mfma_f32_16x16x32_bf16 v[168:171], v[76:79], v[212:215], 0
    v_mfma_f32_16x16x32_bf16 v[176:179], v[76:79], v[216:219], 0
    v_mfma_f32_16x16x32_bf16 v[164:167], v[80:83], v[216:219], v[164:167]
    v_mfma_f32_16x16x32_bf16 v[172:175], v[88:91], v[212:215], v[172:175]
    v_mfma_f32_16x16x32_bf16 v[168:171], v[84:87], v[216:219], v[168:171]
    v_mfma_f32_16x16x32_bf16 v[176:179], v[92:95], v[212:215], v[176:179]
    s_nop 4
    v_pk_mul_f32 v[196:197], v[164:165], v[180:181]
    v_pk_mul_f32 v[204:205], v[164:165], v[188:189] neg_lo:[1,0] neg_hi:[1,0]
    v_pk_mul_f32 v[198:199], v[166:167], v[182:183]
    v_pk_mul_f32 v[206:207], v[166:167], v[190:191] neg_lo:[1,0] neg_hi:[1,0]
    v_pk_mul_f32 v[200:201], v[168:169], v[184:185]
    v_pk_mul_f32 v[208:209], v[168:169], v[192:193] neg_lo:[1,0] neg_hi:[1,0]
    v_pk_mul_f32 v[202:203], v[170:171], v[186:187]
    v_pk_mul_f32 v[210:211], v[170:171], v[194:195] neg_lo:[1,0] neg_hi:[1,0]
    v_pk_fma_f32 v[196:197], v[172:173], v[188:189], v[196:197] neg_lo:[1,0,0] neg_hi:[1,0,0]
    v_pk_fma_f32 v[204:205], v[172:173], v[180:181], v[204:205] neg_lo:[1,0,0] neg_hi:[1,0,0]
    v_pk_fma_f32 v[198:199], v[174:175], v[190:191], v[198:199] neg_lo:[1,0,0] neg_hi:[1,0,0]
    v_pk_fma_f32 v[206:207], v[174:175], v[182:183], v[206:207] neg_lo:[1,0,0] neg_hi:[1,0,0]
    v_pk_fma_f32 v[200:201], v[176:177], v[192:193], v[200:201] neg_lo:[1,0,0] neg_hi:[1,0,0]
    v_pk_fma_f32 v[208:209], v[176:177], v[184:185], v[208:209] neg_lo:[1,0,0] neg_hi:[1,0,0]
    v_pk_fma_f32 v[202:203], v[178:179], v[194:195], v[202:203] neg_lo:[1,0,0] neg_hi:[1,0,0]
    v_pk_fma_f32 v[210:211], v[178:179], v[186:187], v[210:211] neg_lo:[1,0,0] neg_hi:[1,0,0]
    v_cvt_pk_bf16_f32 v212, v196, v197
    v_cvt_pk_bf16_f32 v213, v198, v199
    v_cvt_pk_bf16_f32 v214, v200, v201
    v_cvt_pk_bf16_f32 v215, v202, v203
    v_cvt_pk_bf16_f32 v216, v204, v205
    v_cvt_pk_bf16_f32 v217, v206, v207
    v_cvt_pk_bf16_f32 v218, v208, v209
    v_cvt_pk_bf16_f32 v219, v210, v211
    v_mfma_f32_16x16x32_bf16 v[164:167], v[212:215], v[72:75], 0
    s_nop 0
    v_mfma_f32_16x16x32_bf16 v[172:175], v[216:219], v[72:75], 0
    v_mfma_f32_16x16x32_bf16 v[168:171], v[212:215], v[76:79], 0
    v_mfma_f32_16x16x32_bf16 v[176:179], v[216:219], v[76:79], 0
    v_mfma_f32_16x16x32_bf16 v[164:167], v[216:219], v[80:83], v[164:167]
    v_mfma_f32_16x16x32_bf16 v[172:175], v[212:215], v[88:91], v[172:175]
    v_mfma_f32_16x16x32_bf16 v[168:171], v[216:219], v[84:87], v[168:171]
    v_mfma_f32_16x16x32_bf16 v[176:179], v[212:215], v[92:95], v[176:179]
    s_waitcnt vmcnt(8)
    ds_read_b64_tr_b16 v[16:17], v12
    ds_read_b64_tr_b16 v[18:19], v12 offset:1024
    ds_read_b64_tr_b16 v[20:21], v13
    ds_read_b64_tr_b16 v[22:23], v13 offset:1024
    s_waitcnt lgkmcnt(0)
    s_cmp_lt_u32 s39, 896
    s_cbranch_scc0 L_kB_kernel_now2p
    buffer_store_dwordx4 v[16:19], v6, s[40:43], s36 offen sc1
    buffer_store_dwordx4 v[20:23], v6, s[40:43], s37 offen sc1
L_kB_kernel_now2p:
    v_pk_mul_f32 v[196:197], v[164:165], v[112:113]
    v_pk_mul_f32 v[204:205], v[172:173], v[112:113]
    v_pk_mul_f32 v[198:199], v[166:167], v[114:115]
    v_pk_mul_f32 v[206:207], v[174:175], v[114:115]
    v_pk_mul_f32 v[200:201], v[168:169], v[116:117]
    v_pk_mul_f32 v[208:209], v[176:177], v[116:117]
    v_pk_mul_f32 v[202:203], v[170:171], v[118:119]
    v_pk_mul_f32 v[210:211], v[178:179], v[118:119]
    v_pk_fma_f32 v[196:197], v[172:173], v[120:121], v[196:197]
    v_pk_fma_f32 v[204:205], v[164:165], v[120:121], v[204:205] neg_lo:[1,0,0] neg_hi:[1,0,0]
    v_pk_fma_f32 v[198:199], v[174:175], v[122:123], v[198:199]
    v_pk_fma_f32 v[206:207], v[166:167], v[122:123], v[206:207] neg_lo:[1,0,0] neg_hi:[1,0,0]
    v_pk_fma_f32 v[200:201], v[176:177], v[124:125], v[200:201]
    v_pk_fma_f32 v[208:209], v[168:169], v[124:125], v[208:209] neg_lo:[1,0,0] neg_hi:[1,0,0]
    v_pk_fma_f32 v[202:203], v[178:179], v[126:127], v[202:203]
    v_pk_fma_f32 v[210:211], v[170:171], v[126:127], v[210:211] neg_lo:[1,0,0] neg_hi:[1,0,0]
    v_cvt_pk_bf16_f32 v220, v196, v204
    v_cvt_pk_bf16_f32 v221, v197, v205
    v_cvt_pk_bf16_f32 v222, v198, v206
    v_cvt_pk_bf16_f32 v223, v199, v207
    v_cvt_pk_bf16_f32 v224, v200, v208
    v_cvt_pk_bf16_f32 v225, v201, v209
    v_cvt_pk_bf16_f32 v226, v202, v210
    v_cvt_pk_bf16_f32 v227, v203, v211
    s_lshl_b32 s23, s16, 10
    s_add_u32 s23, s23, 139264
    v_add_u32 v228, s23, v6
    ds_write_b128 v228, v[220:223]
    ds_write_b128 v228, v[224:227] offset:4096
    v_add_u32 v229, 139264, v6
    v_add_u32 v7, s22, v4
    v_lshlrev_b32 v230, 7, v7
    v_lshl_add_u32 v230, v5, 4, v230
    s_mul_i32 s17, s2, 8320
    s_add_u32 s24, s17, 0
    s_waitcnt lgkmcnt(0)
    s_barrier
    ds_read_b128 v[132:135], v229 offset:0
    ds_read_b128 v[148:151], v229 offset:4096
    ds_read_b128 v[136:139], v229 offset:1024
    ds_read_b128 v[152:155], v229 offset:5120
    ds_read_b128 v[140:143], v229 offset:2048
    ds_read_b128 v[156:159], v229 offset:6144
    ds_read_b128 v[144:147], v229 offset:3072
    ds_read_b128 v[160:163], v229 offset:7168
    s_waitcnt lgkmcnt(6)
    v_mfma_f32_16x16x32_bf16 v[164:167], v[132:135], v[40:43], 0
    v_mfma_f32_16x16x32_bf16 v[172:175], v[132:135], v[56:59], 0
    v_mfma_f32_16x16x32_bf16 v[168:171], v[148:151], v[40:43], 0
    v_mfma_f32_16x16x32_bf16 v[176:179], v[148:151], v[56:59], 0
    s_waitcnt lgkmcnt(4)
    v_mfma_f32_16x16x32_bf16 v[164:167], v[136:139], v[44:47], v[164:167]
    v_mfma_f32_16x16x32_bf16 v[172:175], v[136:139], v[60:63], v[172:175]
    v_mfma_f32_16x16x32_bf16 v[168:171], v[152:155], v[44:47], v[168:171]
    v_mfma_f32_16x16x32_bf16 v[176:179], v[152:155], v[60:63], v[176:179]
    s_waitcnt lgkmcnt(2)
    v_mfma_f32_16x16x32_bf16 v[164:167], v[140:143], v[48:51], v[164:167]
    v_mfma_f32_16x16x32_bf16 v[172:175], v[140:143], v[64:67], v[172:175]
    v_mfma_f32_16x16x32_bf16 v[168:171], v[156:159], v[48:51], v[168:171]
    v_mfma_f32_16x16x32_bf16 v[176:179], v[156:159], v[64:67], v[176:179]
    s_waitcnt lgkmcnt(0)
    v_mfma_f32_16x16x32_bf16 v[164:167], v[144:147], v[52:55], v[164:167]
    v_mfma_f32_16x16x32_bf16 v[172:175], v[144:147], v[68:71], v[172:175]
    v_mfma_f32_16x16x32_bf16 v[168:171], v[160:163], v[52:55], v[168:171]
    v_mfma_f32_16x16x32_bf16 v[176:179], v[160:163], v[68:71], v[176:179]
    s_nop 5
    v_cvt_pk_bf16_f32 v220, v164, -v172
    v_cvt_pk_bf16_f32 v221, v165, -v173
    v_cvt_pk_bf16_f32 v222, v166, -v174
    v_cvt_pk_bf16_f32 v223, v167, -v175
    v_cvt_pk_bf16_f32 v224, v168, -v176
    v_cvt_pk_bf16_f32 v225, v169, -v177
    v_cvt_pk_bf16_f32 v226, v170, -v178
    v_cvt_pk_bf16_f32 v227, v171, -v179
    v_and_b32 v220, -2, v220
    v_and_b32 v221, -2, v221
    v_and_b32 v222, -2, v222
    v_and_b32 v223, -2, v223
    v_and_b32 v224, -2, v224
    v_and_b32 v225, -2, v225
    v_and_b32 v226, -2, v226
    v_and_b32 v227, -2, v227
    s_waitcnt vmcnt(0)
    buffer_store_dwordx4 v[220:223], v230, s[40:43], s24 offen sc1
    buffer_store_dwordx4 v[224:227], v230, s[40:43], s24 offen offset:64 sc1
    s_lshl_b32 s17, s56, 7
    s_add_u32 s17, s17, 22331392
    v_mov_b32 v16, s17
    s_lshl_b32 s17, s56, 8
    s_lshl_b32 s18, s57, 3
    s_add_u32 s17, s17, s18
    v_lshrrev_b32 v7, 1, v3
    s_lshl_b32 s18, s16, 6
    v_add_u32 v7, s18, v7
    v_add_u32 v8, 31, v7
    v_add_u32 v7, 255, v7
    v_and_b32 v7, 255, v7
    s_mov_b32 s18, 8320
    v_mul_lo_u32 v56, v7, s18
    v_mul_lo_u32 v58, v8, s18
    v_and_b32 v7, 1, v3
    v_lshl_add_u32 v56, v7, 4, v56
    v_lshl_add_u32 v58, v7, 4, v58
    s_lshl_b32 s19, s17, 2
    s_add_u32 s19, s19, 0
    s_lshl_b32 s21, s16, 11
    s_add_u32 s21, s21, 131072
    v_add_u32 v57, s21, v6
    v_lshlrev_b32 v59, 6, v4
    v_lshl_add_u32 v59, v5, 3, v59
    s_lshl_b32 s22, s16, 1
    s_add_u32 s22, s22, s17
    s_lshl_b32 s23, s22, 10
    v_lshlrev_b32 v60, 5, v4
    v_lshl_add_u32 v60, v5, 11, v60
    s_lshl_b32 s24, s16, 3
    s_add_u32 s24, s24, 131072
    v_add_u32 v60, s24, v60
    v_add_u32 v61, 4, v60
    v_lshl_add_u32 v7, v4, 2, v5
    v_lshlrev_b32 v62, 7, v7
    v_and_b32 v7, 7, v4
    s_lshl_b32 s18, s16, 1
    v_xor_b32 v7, s18, v7
    v_lshl_add_u32 v62, v7, 4, v62
    v_add_u32 v62, 139264, v62
    s_lshr_b32 s25, s17, 5
    s_lshl_b32 s25, s25, 15
    s_and_b32 s26, s17, 31
    s_lshl_b32 s26, s26, 4
    s_add_u32 s25, s25, s26
    s_add_u32 s26, s25, 8486912
    s_add_u32 s25, s25, 6389760
    buffer_load_dwordx2 v[64:65], v59, s[28:31], s23 offen offset:0
    buffer_load_dwordx2 v[66:67], v59, s[28:31], s23 offen offset:32
    buffer_load_dwordx2 v[68:69], v59, s[28:31], s23 offen offset:1024
    buffer_load_dwordx2 v[70:71], v59, s[28:31], s23 offen offset:1056
    v_and_b32 v7, 31, v3
    v_lshlrev_b32 v7, 1, v7
    v_cmp_lt_u32 vcc, 31, v3
    v_mov_b32 v8, 0x7ffffff0
    s_nop 0
    v_cndmask_b32 v7, v7, v8, vcc
    s_min_u32 s18, s60, 13
    s_lshl_b32 s18, s18, 8
    buffer_load_ushort v72, v7, s[48:51], s18 offen offset:0
    buffer_load_ushort v73, v7, s[48:51], s18 offen offset:64
    buffer_load_ushort v74, v7, s[48:51], s18 offen offset:128
    buffer_load_ushort v75, v7, s[48:51], s18 offen offset:192
    s_add_u32 m0, s68, 32768
    s_add_u32 s62, s61, 458752
    buffer_load_dwordx4 v10, s[44:47], s62 offen lds
    v_cvt_f32_u32 v119, v4
    v_lshlrev_b32 v8, 2, v5
    v_cvt_f32_u32 v120, v8
    v_mov_b32 v96, v120
    s_add_u32 m0, s68, 36864
    s_add_u32 s62, s61, 516096
    buffer_load_dwordx4 v10, s[44:47], s62 offen lds
    v_add_f32 v97, 1.0, v120
    v_add_f32 v98, 2.0, v120
    v_add_f32 v99, 3.0, v120
    v_mul_f32 v7, 0x3d000000, v119
    s_add_u32 m0, s68, 40960
    s_add_u32 s62, s61, 573440
    buffer_load_dwordx4 v10, s[44:47], s62 offen lds
    v_mul_f32 v100, v7, v96
    v_mul_f32 v101, v7, v97
    v_mul_f32 v102, v7, v98
    v_mul_f32 v103, v7, v99
    s_add_u32 m0, s68, 45056
    s_add_u32 s62, s61, 630784
    buffer_load_dwordx4 v10, s[44:47], s62 offen lds
    v_cos_f32 v108, v100
    v_sin_f32 v112, v100
    v_cos_f32 v109, v101
    v_sin_f32 v113, v101
    s_add_u32 m0, s68, 49152
    s_add_u32 s62, s61, 688128
    buffer_load_dwordx4 v10, s[44:47], s62 offen lds
    v_cos_f32 v110, v102
    v_sin_f32 v114, v102
    v_cos_f32 v111, v103
    v_sin_f32 v115, v103
    s_add_u32 m0, s68, 53248
    s_add_u32 s62, s61, 745472
    buffer_load_dwordx4 v10, s[44:47], s62 offen lds
    v_cvt_pk_bf16_f32 v20, v108, -v112
    v_cvt_pk_bf16_f32 v28, v112, v108
    v_cvt_pk_bf16_f32 v21, v109, -v113
    v_cvt_pk_bf16_f32 v29, v113, v109
    s_add_u32 m0, s68, 57344
    s_add_u32 s62, s61, 802816
    buffer_load_dwordx4 v10, s[44:47], s62 offen lds
    v_cvt_pk_bf16_f32 v22, v110, -v114
    v_cvt_pk_bf16_f32 v30, v114, v110
    v_cvt_pk_bf16_f32 v23, v111, -v115
    v_cvt_pk_bf16_f32 v31, v115, v111
    s_add_u32 m0, s68, 61440
    s_add_u32 s62, s61, 860160
    buffer_load_dwordx4 v10, s[44:47], s62 offen lds
    v_mov_b32 v24, v20
    v_mov_b32 v32, v28
    v_xor_b32 v25, 0x80008000, v21
    s_add_u32 m0, s68, 65536
    s_add_u32 s62, s61, 917504
    buffer_load_dwordx4 v10, s[44:47], s62 offen lds
    v_xor_b32 v33, 0x80008000, v29
    v_mov_b32 v26, v22
    v_mov_b32 v34, v30
    s_add_u32 m0, s68, 69632
    s_add_u32 s62, s61, 974848
    buffer_load_dwordx4 v10, s[44:47], s62 offen lds
    v_xor_b32 v27, 0x80008000, v23
    v_xor_b32 v35, 0x80008000, v31
    v_mul_f32 v7, 0x3b000000, v119
    s_add_u32 m0, s68, 73728
    s_add_u32 s62, s61, 1032192
    buffer_load_dwordx4 v10, s[44:47], s62 offen lds
    v_add_f32 v8, 0x3d000000, v7
    v_mul_f32 v100, v7, v96
    v_mul_f32 v104, v8, v96
    s_add_u32 m0, s68, 77824
    s_add_u32 s62, s61, 1089536
    buffer_load_dwordx4 v10, s[44:47], s62 offen lds
    v_mul_f32 v101, v7, v97
    v_mul_f32 v105, v8, v97
    v_mul_f32 v102, v7, v98
    s_add_u32 m0, s68, 81920
    s_add_u32 s62, s61, 1146880
    buffer_load_dwordx4 v10, s[44:47], s62 offen lds
    v_mul_f32 v106, v8, v98
    v_mul_f32 v103, v7, v99
    v_mul_f32 v107, v8, v99
    s_add_u32 m0, s68, 86016
    s_add_u32 s62, s61, 1204224
    buffer_load_dwordx4 v10, s[44:47], s62 offen lds
    v_cos_f32 v40, v100
    v_sin_f32 v48, -v100
    v_cos_f32 v41, v101
    s_add_u32 m0, s68, 90112
    s_add_u32 s62, s61, 1261568
    buffer_load_dwordx4 v10, s[44:47], s62 offen lds
    v_sin_f32 v49, -v101
    v_cos_f32 v42, v102
    v_sin_f32 v50, -v102
    s_add_u32 m0, s68, 94208
    s_add_u32 s62, s61, 1318912
    buffer_load_dwordx4 v10, s[44:47], s62 offen lds
    v_cos_f32 v43, v103
    v_sin_f32 v51, -v103
    v_cos_f32 v44, v104
    s_add_u32 m0, s68, 98304
    s_add_u32 s62, s61, 1376256
    buffer_load_dwordx4 v10, s[44:47], s62 offen lds
    v_sin_f32 v52, -v104
    v_cos_f32 v45, v105
    v_sin_f32 v53, -v105
    s_add_u32 m0, s68, 102400
    s_add_u32 s62, s61, 1433600
    buffer_load_dwordx4 v10, s[44:47], s62 offen lds
    v_cos_f32 v46, v106
    v_sin_f32 v54, -v106
    v_cos_f32 v47, v107
    s_add_u32 m0, s68, 106496
    s_add_u32 s62, s61, 1490944
    buffer_load_dwordx4 v10, s[44:47], s62 offen lds
    v_sin_f32 v55, -v107
    v_mul_f32 v7, 0x3d800000, v119
    v_mul_f32 v100, v7, v96
    s_add_u32 m0, s68, 110592
    s_add_u32 s62, s61, 1548288
    buffer_load_dwordx4 v10, s[44:47], s62 offen lds
    v_mul_f32 v101, v7, v97
    v_mul_f32 v102, v7, v98
    v_mul_f32 v103, v7, v99
    s_add_u32 m0, s68, 114688
    s_add_u32 s62, s61, 1605632
    buffer_load_dwordx4 v10, s[44:47], s62 offen lds
    v_cos_f32 v108, v100
    v_sin_f32 v112, v100
    v_cos_f32 v109, v101
    s_add_u32 m0, s68, 118784
    s_add_u32 s62, s61, 1662976
    buffer_load_dwordx4 v10, s[44:47], s62 offen lds
    v_sin_f32 v113, v101
    v_cos_f32 v110, v102
    v_sin_f32 v114, v102
    s_add_u32 m0, s68, 122880
    s_add_u32 s62, s61, 1720320
    buffer_load_dwordx4 v10, s[44:47], s62 offen lds
    v_cos_f32 v111, v103
    v_sin_f32 v115, v103
    v_cvt_pk_bf16_f32 v36, v108, v109
    s_add_u32 m0, s68, 126976
    s_add_u32 s62, s61, 1777664
    buffer_load_dwordx4 v10, s[44:47], s62 offen lds
    v_cvt_pk_bf16_f32 v37, v110, v111
    v_cvt_pk_bf16_f32 v38, -v112, -v113
    v_cvt_pk_bf16_f32 v39, -v114, -v115
    s_waitcnt vmcnt(28)
    v_lshlrev_b32 v76, 16, v64
    v_and_b32 v77, 0xffff0000, v64
    v_lshlrev_b32 v78, 16, v65
    v_and_b32 v79, 0xffff0000, v65
    v_lshlrev_b32 v80, 16, v66
    v_and_b32 v81, 0xffff0000, v66
    v_lshlrev_b32 v82, 16, v67
    v_and_b32 v83, 0xffff0000, v67
    v_lshlrev_b32 v84, 16, v68
    v_and_b32 v85, 0xffff0000, v68
    v_lshlrev_b32 v86, 16, v69
    v_and_b32 v87, 0xffff0000, v69
    v_lshlrev_b32 v88, 16, v70
    v_and_b32 v89, 0xffff0000, v70
    v_lshlrev_b32 v90, 16, v71
    v_and_b32 v91, 0xffff0000, v71
    v_lshrrev_b32 v9, 3, v3
    s_lshl_b32 s27, s16, 4
    v_add_u32 v9, s27, v9
    v_and_b32 v94, 7, v3
    v_add_u32 v92, 0, v9
    v_bfe_u32 v1, v92, 2, 3
    v_xor_b32 v1, v1, v94
    v_lshlrev_b32 v92, 7, v92
    v_lshl_add_u32 v92, v1, 4, v92
    v_add_u32 v92, 139264, v92
    v_add_u32 v93, 8, v9
    v_bfe_u32 v1, v93, 2, 3
    v_xor_b32 v1, v1, v94
    v_lshlrev_b32 v93, 7, v93
    v_lshl_add_u32 v93, v1, 4, v93
    v_add_u32 v93, 139264, v93
    v_lshlrev_b32 v94, 4, v94
    v_lshl_add_u32 v94, v9, 9, v94
    s_waitcnt vmcnt(24)
    v_lshlrev_b32 v12, 16, v72
    v_mul_f32 v12, 0x3fb8aa3b, v12
    v_lshlrev_b32 v13, 16, v73
    v_mul_f32 v13, 0x3fb8aa3b, v13
    v_lshlrev_b32 v14, 16, v74
    v_mul_f32 v14, 0x3fb8aa3b, v14
    v_lshlrev_b32 v15, 16, v75
    v_mul_f32 v15, 0x3fb8aa3b, v15
    v_cvt_pk_bf16_f32 v7, v12, v12
    v_lshlrev_b32 v8, 16, v7
    v_sub_f32 v8, v12, v8
    v_cvt_pk_bf16_f32 v8, v8, v8
    v_and_b32 v7, 0xffff, v7
    v_lshl_or_b32 v12, v8, 16, v7
    v_cvt_pk_bf16_f32 v7, v13, v13
    v_lshlrev_b32 v8, 16, v7
    v_sub_f32 v8, v13, v8
    v_cvt_pk_bf16_f32 v8, v8, v8
    v_and_b32 v7, 0xffff, v7
    v_lshl_or_b32 v13, v8, 16, v7
    v_cvt_pk_bf16_f32 v7, v14, v14
    v_lshlrev_b32 v8, 16, v7
    v_sub_f32 v8, v14, v8
    v_cvt_pk_bf16_f32 v8, v8, v8
    v_and_b32 v7, 0xffff, v7
    v_lshl_or_b32 v14, v8, 16, v7
    v_cvt_pk_bf16_f32 v7, v15, v15
    v_lshlrev_b32 v8, 16, v7
    v_sub_f32 v8, v15, v8
    v_cvt_pk_bf16_f32 v8, v8, v8
    v_and_b32 v7, 0xffff, v7
    v_lshl_or_b32 v15, v8, 16, v7
    s_lshl_b32 s17, s56, 3
    s_lshl_b32 s18, s59, 2
    s_add_u32 s17, s17, s18
    s_add_u32 s17, s17, s16
    s_lshl_b32 s8, s17, 15
    s_add_u32 s8, s8, 6389760
    s_mul_i32 s9, s17, 123904
    s_add_u32 s9, s9, 10584064
    s_lshl_b32 s18, s60, 3
    s_add_u32 s18, s18, 0
    s_mul_i32 s17, s18, 2341
    s_lshr_b32 s17, s17, 16
    s_lshl_b32 s17, s17, 11
    s_lshl_b32 s18, s18, 10
    s_add_u32 s18, s18, s17
    s_add_u32 s4, s18, s9
    s_lshl_b32 s18, s60, 3
    s_add_u32 s18, s18, 2
    s_mul_i32 s17, s18, 2341
    s_lshr_b32 s17, s17, 16
    s_lshl_b32 s17, s17, 11
    s_lshl_b32 s18, s18, 10
    s_add_u32 s18, s18, s17
    s_add_u32 s5, s18, s9
    s_lshl_b32 s18, s60, 3
    s_add_u32 s18, s18, 4
    s_mul_i32 s17, s18, 2341
    s_lshr_b32 s17, s17, 16
    s_lshl_b32 s17, s17, 11
    s_lshl_b32 s18, s18, 10
    s_add_u32 s18, s18, s17
    s_add_u32 s6, s18, s9
    s_lshl_b32 s18, s60, 3
    s_add_u32 s18, s18, 6
    s_mul_i32 s17, s18, 2341
    s_lshr_b32 s17, s17, 16
    s_lshl_b32 s17, s17, 11
    s_lshl_b32 s18, s18, 10
    s_add_u32 s18, s18, s17
    s_add_u32 s7, s18, s9
    v_lshlrev_b32 v11, 2, v4
    s_lshl_b32 s18, s56, 7
    s_lshl_b32 s17, s59, 6
    s_add_u32 s18, s18, s17
    s_add_u32 s18, s18, 22332416
    v_add_u32 v11, s18, v11
    s_mov_b32 s17, 0
L_kB_kernel_ypoll:
    buffer_load_dwordx4 v[96:99], v56, s[40:43], s19 offen sc1
    buffer_load_dwordx4 v[100:103], v58, s[40:43], s19 offen sc1
    s_waitcnt vmcnt(0)
    v_or3_b32 v1, v96, v97, v98
    v_or3_b32 v2, v100, v101, v102
    v_or3_b32 v1, v1, v99, v103
    v_or_b32 v1, v1, v2
    v_and_b32 v1, 1, v1
    v_cmp_eq_u32 vcc, 1, v1
    s_nop 4
    s_cbranch_vccz L_kB_kernel_yok
    s_mov_b64 exec, vcc
    s_add_u32 s17, s17, 1
    s_cmp_lt_u32 s17, 400000
    s_cbranch_scc1 L_kB_kernel_ypoll
L_kB_kernel_yok:
    s_mov_b64 exec, -1
    ds_write_b128 v57, v[96:99]
    ds_write_b128 v57, v[100:103] offset:1024
    s_waitcnt lgkmcnt(0)
    s_barrier
    ds_read2st64_b32 v[96:97], v60 offset0:0 offset1:2
    ds_read2st64_b32 v[98:99], v60 offset0:4 offset1:6
    ds_read2st64_b32 v[100:101], v61 offset0:0 offset1:2
    ds_read2st64_b32 v[102:103], v61 offset0:4 offset1:6
    s_cmp_eq_u32 s16, 0
    s_cbranch_scc0 L_kB_kernel_nocnt
    buffer_load_dwordx2 v[56:57], v16, s[40:43], 0 offen sc1
L_kB_kernel_nocnt:
    s_waitcnt lgkmcnt(0)
    v_readlane_b32 s32, v96, 0
    v_readlane_b32 s36, v100, 0
    v_writelane_b32 v96, 0, 0
    s_lshl_b32 s32, s32, 16
    s_add_u32 s65, s63, 0
    buffer_load_dwordx4 a[0:3], v6, s[40:43], s65 offen offset:0
    s_xor_b32 s33, s32, 0x80000000
    v_writelane_b32 v100, 0, 0
    s_lshl_b32 s36, s36, 16
    s_xor_b32 s37, s36, 0x80000000
    v_mfma_f32_16x16x32_bf16 v[104:107], v[96:99], v[20:23], 0
    v_mfma_f32_16x16x32_bf16 v[108:111], v[96:99], v[28:31], 0
    v_mfma_f32_16x16x32_bf16 v[112:115], v[96:99], v[24:27], 0
    v_mfma_f32_16x16x32_bf16 v[116:119], v[96:99], v[32:35], 0
    v_mfma_f32_16x16x32_bf16 v[120:123], v[100:103], v[20:23], 0
    v_mfma_f32_16x16x32_bf16 v[124:127], v[100:103], v[28:31], 0
    buffer_load_dwordx4 a[8:11], v6, s[40:43], s65 offen offset:1024
    v_mfma_f32_16x16x32_bf16 v[128:131], v[100:103], v[24:27], 0
    v_mfma_f32_16x16x32_bf16 v[132:135], v[100:103], v[32:35], 0
    v_pk_mul_f32 v[136:137], v[104:105], v[40:41]
    v_pk_mul_f32 v[144:145], v[108:109], v[40:41]
    v_pk_mul_f32 v[138:139], v[106:107], v[42:43]
    v_pk_mul_f32 v[146:147], v[110:111], v[42:43]
    v_pk_mul_f32 v[140:141], v[112:113], v[44:45]
    v_pk_mul_f32 v[148:149], v[116:117], v[44:45]
    v_pk_mul_f32 v[142:143], v[114:115], v[46:47]
    v_pk_mul_f32 v[150:151], v[118:119], v[46:47]
    buffer_load_dwordx4 a[16:19], v6, s[40:43], s65 offen offset:2048
    v_pk_fma_f32 v[136:137], v[108:109], v[48:49], v[136:137]
    v_pk_fma_f32 v[144:145], v[104:105], v[48:49], v[144:145] neg_lo:[1,0,0] neg_hi:[1,0,0]
    v_pk_fma_f32 v[138:139], v[110:111], v[50:51], v[138:139]
    v_pk_fma_f32 v[146:147], v[106:107], v[50:51], v[146:147] neg_lo:[1,0,0] neg_hi:[1,0,0]
    v_pk_fma_f32 v[140:141], v[116:117], v[52:53], v[140:141]
    v_pk_fma_f32 v[148:149], v[112:113], v[52:53], v[148:149] neg_lo:[1,0,0] neg_hi:[1,0,0]
    v_pk_fma_f32 v[142:143], v[118:119], v[54:55], v[142:143]
    v_pk_fma_f32 v[150:151], v[114:115], v[54:55], v[150:151] neg_lo:[1,0,0] neg_hi:[1,0,0]
    v_cvt_pk_bf16_f32 v104, v136, v137
    v_cvt_pk_bf16_f32 v105, v138, v139
    buffer_load_dwordx4 a[24:27], v6, s[40:43], s65 offen offset:3072
    v_cvt_pk_bf16_f32 v106, v144, v145
    v_cvt_pk_bf16_f32 v107, v146, v147
    v_cvt_pk_bf16_f32 v108, v140, v141
    v_cvt_pk_bf16_f32 v109, v142, v143
    v_cvt_pk_bf16_f32 v110, v148, v149
    v_cvt_pk_bf16_f32 v111, v150, v151
    v_mfma_f32_16x16x32_bf16 v[112:115], v[104:107], v[36:39], 0
    s_nop 0
    v_mfma_f32_16x16x32_bf16 v[116:119], v[108:111], v[36:39], 0
    v_pk_mul_f32 v[136:137], v[120:121], v[40:41]
    v_pk_mul_f32 v[144:145], v[124:125], v[40:41]
    s_add_u32 s66, s64, 0
    buffer_load_dwordx4 a[4:7], v6, s[40:43], s66 offen offset:0
    v_pk_mul_f32 v[138:139], v[122:123], v[42:43]
    v_pk_mul_f32 v[146:147], v[126:127], v[42:43]
    v_pk_mul_f32 v[140:141], v[128:129], v[44:45]
    v_pk_mul_f32 v[148:149], v[132:133], v[44:45]
    v_pk_mul_f32 v[142:143], v[130:131], v[46:47]
    v_pk_mul_f32 v[150:151], v[134:135], v[46:47]
    v_pk_fma_f32 v[136:137], v[124:125], v[48:49], v[136:137]
    v_pk_fma_f32 v[144:145], v[120:121], v[48:49], v[144:145] neg_lo:[1,0,0] neg_hi:[1,0,0]
    v_pk_fma_f32 v[138:139], v[126:127], v[50:51], v[138:139]
    v_pk_fma_f32 v[146:147], v[122:123], v[50:51], v[146:147] neg_lo:[1,0,0] neg_hi:[1,0,0]
    buffer_load_dwordx4 a[12:15], v6, s[40:43], s66 offen offset:1024
    v_pk_fma_f32 v[140:141], v[132:133], v[52:53], v[140:141]
    v_pk_fma_f32 v[148:149], v[128:129], v[52:53], v[148:149] neg_lo:[1,0,0] neg_hi:[1,0,0]
    v_pk_fma_f32 v[142:143], v[134:135], v[54:55], v[142:143]
    v_pk_fma_f32 v[150:151], v[130:131], v[54:55], v[150:151] neg_lo:[1,0,0] neg_hi:[1,0,0]
    v_cvt_pk_bf16_f32 v120, v136, v137
    v_cvt_pk_bf16_f32 v121, v138, v139
    v_cvt_pk_bf16_f32 v122, v144, v145
    v_cvt_pk_bf16_f32 v123, v146, v147
    v_cvt_pk_bf16_f32 v124, v140, v141
    v_cvt_pk_bf16_f32 v125, v142, v143
    buffer_load_dwordx4 a[20:23], v6, s[40:43], s66 offen offset:2048
    v_cvt_pk_bf16_f32 v126, v148, v149
    v_cvt_pk_bf16_f32 v127, v150, v151
    v_mfma_f32_16x16x32_bf16 v[128:131], v[120:123], v[36:39], 0
    s_nop 0
    v_mfma_f32_16x16x32_bf16 v[132:135], v[124:127], v[36:39], 0
    v_pk_add_f32 v[76:77], v[76:77], s[32:33]
    v_pk_add_f32 v[78:79], v[78:79], s[32:33]
    v_pk_add_f32 v[80:81], v[80:81], s[32:33]
    v_pk_add_f32 v[82:83], v[82:83], s[32:33]
    v_pk_add_f32 v[84:85], v[84:85], s[36:37]
    v_pk_add_f32 v[86:87], v[86:87], s[36:37]
    buffer_load_dwordx4 a[28:31], v6, s[40:43], s66 offen offset:3072
    v_pk_add_f32 v[88:89], v[88:89], s[36:37]
    v_pk_add_f32 v[90:91], v[90:91], s[36:37]
    v_pk_add_f32 v[76:77], v[76:77], v[112:113]
    v_pk_add_f32 v[78:79], v[78:79], v[114:115]
    v_pk_add_f32 v[80:81], v[80:81], v[116:117]
    v_pk_add_f32 v[82:83], v[82:83], v[118:119]
    v_pk_add_f32 v[84:85], v[84:85], v[128:129]
    v_pk_add_f32 v[86:87], v[86:87], v[130:131]
    v_pk_add_f32 v[88:89], v[88:89], v[132:133]
    v_pk_add_f32 v[90:91], v[90:91], v[134:135]
    s_add_u32 s65, s63, 4096
    buffer_load_dwordx4 a[32:35], v6, s[40:43], s65 offen offset:0
    v_pk_add_f32 v[112:113], v[76:77], v[78:79]
    v_pk_mul_f32 v[114:115], v[76:77], v[76:77]
    v_pk_add_f32 v[128:129], v[84:85], v[86:87]
    v_pk_mul_f32 v[130:131], v[84:85], v[84:85]
    v_pk_add_f32 v[112:113], v[112:113], v[80:81]
    v_pk_add_f32 v[128:129], v[128:129], v[88:89]
    v_pk_add_f32 v[112:113], v[112:113], v[82:83]
    v_pk_add_f32 v[128:129], v[128:129], v[90:91]
    v_pk_fma_f32 v[114:115], v[78:79], v[78:79], v[114:115]
    v_pk_fma_f32 v[130:131], v[86:87], v[86:87], v[130:131]
    buffer_load_dwordx4 a[40:43], v6, s[40:43], s65 offen offset:1024
    v_pk_fma_f32 v[114:115], v[80:81], v[80:81], v[114:115]
    v_pk_fma_f32 v[130:131], v[88:89], v[88:89], v[130:131]
    v_pk_fma_f32 v[114:115], v[82:83], v[82:83], v[114:115]
    v_pk_fma_f32 v[130:131], v[90:91], v[90:91], v[130:131]
    v_add_f32 v96, v112, v113
    v_add_f32 v98, v114, v115
    v_add_f32 v97, v128, v129
    v_add_f32 v99, v130, v131
    v_cvt_pk_bf16_f32 v104, v76, v77
    v_cvt_pk_bf16_f32 v105, v78, v79
    buffer_load_dwordx4 a[48:51], v6, s[40:43], s65 offen offset:2048
    v_cvt_pk_bf16_f32 v106, v80, v81
    v_cvt_pk_bf16_f32 v107, v82, v83
    v_cvt_pk_bf16_f32 v108, v84, v85
    v_cvt_pk_bf16_f32 v109, v86, v87
    v_cvt_pk_bf16_f32 v110, v88, v89
    v_cvt_pk_bf16_f32 v111, v90, v91
    v_xor_b32 v58, 16, v62
    ds_write_b128 v62, v[104:107] offset:8192
    ds_write_b128 v58, v[108:111] offset:8192
    v_add_f32 v96, v96, v96 row_shr:1 row_mask:0xf bank_mask:0xf bound_ctrl:0
    buffer_load_dwordx4 a[56:59], v6, s[40:43], s65 offen offset:3072
    v_add_f32 v97, v97, v97 row_shr:1 row_mask:0xf bank_mask:0xf bound_ctrl:0
    v_add_f32 v98, v98, v98 row_shr:1 row_mask:0xf bank_mask:0xf bound_ctrl:0
    v_add_f32 v99, v99, v99 row_shr:1 row_mask:0xf bank_mask:0xf bound_ctrl:0
    v_add_f32 v96, v96, v96 row_shr:2 row_mask:0xf bank_mask:0xf bound_ctrl:0
    v_add_f32 v97, v97, v97 row_shr:2 row_mask:0xf bank_mask:0xf bound_ctrl:0
    v_add_f32 v98, v98, v98 row_shr:2 row_mask:0xf bank_mask:0xf bound_ctrl:0
    v_add_f32 v99, v99, v99 row_shr:2 row_mask:0xf bank_mask:0xf bound_ctrl:0
    v_add_f32 v96, v96, v96 row_shr:4 row_mask:0xf bank_mask:0xf bound_ctrl:0
    v_add_f32 v97, v97, v97 row_shr:4 row_mask:0xf bank_mask:0xf bound_ctrl:0
    v_add_f32 v98, v98, v98 row_shr:4 row_mask:0xf bank_mask:0xf bound_ctrl:0
    s_add_u32 s66, s64, 4096
    buffer_load_dwordx4 a[36:39], v6, s[40:43], s66 offen offset:0
    v_add_f32 v99, v99, v99 row_shr:4 row_mask:0xf bank_mask:0xf bound_ctrl:0
    v_add_f32 v96, v96, v96 row_shr:8 row_mask:0xf bank_mask:0xf bound_ctrl:0
    v_add_f32 v97, v97, v97 row_shr:8 row_mask:0xf bank_mask:0xf bound_ctrl:0
    v_add_f32 v98, v98, v98 row_shr:8 row_mask:0xf bank_mask:0xf bound_ctrl:0
    v_add_f32 v99, v99, v99 row_shr:8 row_mask:0xf bank_mask:0xf bound_ctrl:0
    v_add_f32 v96, v96, v96 row_bcast:15 row_mask:0xa bank_mask:0xf
    v_add_f32 v97, v97, v97 row_bcast:15 row_mask:0xa bank_mask:0xf
    v_add_f32 v98, v98, v98 row_bcast:15 row_mask:0xa bank_mask:0xf
    v_add_f32 v99, v99, v99 row_bcast:15 row_mask:0xa bank_mask:0xf
    v_add_f32 v96, v96, v96 row_bcast:31 row_mask:0xc bank_mask:0xf
    buffer_load_dwordx4 a[44:47], v6, s[40:43], s66 offen offset:1024
    v_add_f32 v97, v97, v97 row_bcast:31 row_mask:0xc bank_mask:0xf
    v_add_f32 v98, v98, v98 row_bcast:31 row_mask:0xc bank_mask:0xf
    v_add_f32 v99, v99, v99 row_bcast:31 row_mask:0xc bank_mask:0xf
    s_mov_b32 s27, 0x3b000000
    v_mul_f32 v96, s27, v96
    v_mul_f32 v97, s27, v97
    v_mul_f32 v7, v96, v96
    v_mul_f32 v8, v97, v97
    v_fma_f32 v98, v98, s27, -v7
    v_fma_f32 v99, v99, s27, -v8
    buffer_load_dwordx4 a[52:55], v6, s[40:43], s66 offen offset:2048
    v_max_f32 v98, 0, v98
    v_max_f32 v99, 0, v99
    v_add_f32 v98, 0x3727c5ac, v98
    v_add_f32 v99, 0x3727c5ac, v99
    v_rsq_f32 v98, v98
    v_rsq_f32 v99, v99
    v_mul_f32 v98, 0x3fb8aa3b, v98
    v_mul_f32 v99, 0x3fb8aa3b, v99
    v_mul_f32 v96, -v96, v98
    v_mul_f32 v97, -v97, v99
    buffer_load_dwordx4 a[60:63], v6, s[40:43], s66 offen offset:3072
    v_readlane_b32 s34, v98, 63
    v_readlane_b32 s10, v96, 63
    v_readlane_b32 s35, v99, 63
    v_readlane_b32 s11, v97, 63
    v_mov_b32 v96, s10
    s_nop 0
    v_mov_b32 v97, s11
    v_pk_fma_f32 v[76:77], v[76:77], s[34:35], v[96:97] op_sel:[0,0,0] op_sel_hi:[1,0,0]
    v_pk_fma_f32 v[78:79], v[78:79], s[34:35], v[96:97] op_sel:[0,0,0] op_sel_hi:[1,0,0]
    v_pk_fma_f32 v[80:81], v[80:81], s[34:35], v[96:97] op_sel:[0,0,0] op_sel_hi:[1,0,0]
    v_pk_fma_f32 v[82:83], v[82:83], s[34:35], v[96:97] op_sel:[0,0,0] op_sel_hi:[1,0,0]
    v_pk_fma_f32 v[84:85], v[84:85], s[34:35], v[96:97] op_sel:[0,1,1] op_sel_hi:[1,1,1]
    v_pk_fma_f32 v[86:87], v[86:87], s[34:35], v[96:97] op_sel:[0,1,1] op_sel_hi:[1,1,1]
    v_pk_fma_f32 v[88:89], v[88:89], s[34:35], v[96:97] op_sel:[0,1,1] op_sel_hi:[1,1,1]
    v_pk_fma_f32 v[90:91], v[90:91], s[34:35], v[96:97] op_sel:[0,1,1] op_sel_hi:[1,1,1]
    v_cvt_pk_bf16_f32 v120, v76, v77
    v_cvt_pk_bf16_f32 v121, v78, v79
    v_cvt_pk_bf16_f32 v122, v80, v81
    v_cvt_pk_bf16_f32 v123, v82, v83
    v_cvt_pk_bf16_f32 v124, v84, v85
    v_cvt_pk_bf16_f32 v125, v86, v87
    v_cvt_pk_bf16_f32 v126, v88, v89
    v_cvt_pk_bf16_f32 v127, v90, v91
    ds_write_b128 v62, v[120:123]
    ds_write_b128 v58, v[124:127]
    s_waitcnt lgkmcnt(0)
    s_barrier
    ds_read_b128 v[104:107], v92
    ds_read_b128 v[112:115], v92 offset:8192
    ds_read_b128 v[108:111], v93
    ds_read_b128 v[116:119], v93 offset:8192
    s_add_u32 s17, s25, 4096
    s_add_u32 s18, s26, 4096
    s_waitcnt lgkmcnt(2)
    buffer_store_dwordx4 v[104:107], v94, s[40:43], s25 offen
    buffer_store_dwordx4 v[112:115], v94, s[40:43], s26 offen sc1
    s_waitcnt lgkmcnt(0)
    buffer_store_dwordx4 v[108:111], v94, s[40:43], s17 offen
    buffer_store_dwordx4 v[116:119], v94, s[40:43], s18 offen sc1
    s_mov_b32 s58, 1
    s_cmp_eq_u32 s16, 0
    s_cbranch_scc0 L_kB_kernel_pured
    s_mov_b32 s17, 0
L_kB_kernel_purel:
    s_waitcnt vmcnt(0)
    v_readfirstlane_b32 s18, v56
    v_readfirstlane_b32 s19, v57
    v_sad_u8 v1, v56, 0, 0
    v_sad_u8 v1, v57, 0, v1
    s_lshl_b32 s20, s38, 3
    s_lshr_b64 s[18:19], s[18:19], s20
    s_and_b32 s18, s18, 0xff
    s_cmp_eq_u32 s18, 32
    s_cbranch_scc1 L_kB_kernel_pured
    v_readfirstlane_b32 s18, v1
    s_mov_b32 s58, 0
    s_cmp_ge_u32 s18, 32
    s_cbranch_scc1 L_kB_kernel_pured
    buffer_load_dwordx2 v[56:57], v16, s[40:43], 0 offen sc1
    s_add_u32 s17, s17, 1
    s_cmp_lt_u32 s17, 400000
    s_cbranch_scc1 L_kB_kernel_purel
L_kB_kernel_pured:
    v_mov_b32 v17, 0
    v_mov_b32 v21, 0
    v_mov_b32 v18, 0
    v_mov_b32 v22, 0
    v_mov_b32 v19, 0
    v_mov_b32 v23, 0
    v_mov_b32 v20, 0x3f803f80
    s_waitcnt vmcnt(0)
    s_barrier
    s_cmp_eq_u32 s16, 0
    s_cbranch_scc1 L_kB_kernel_nxw
    buffer_load_dwordx4 v[24:27], v94, s[40:43], s25 offen sc1
    s_add_u32 s17, s25, 4096
    buffer_load_dwordx4 v[28:31], v94, s[40:43], s17 offen sc1
    s_cmp_eq_u32 s16, 1
    s_cbranch_scc0 L_kB_kernel_nxw
    s_sub_u32 s17, s25, 8192
    buffer_load_dwordx4 v[24:27], v94, s[40:43], s17 offen sc1
    s_sub_u32 s17, s25, 4096
    buffer_load_dwordx4 v[28:31], v94, s[40:43], s17 offen sc1
L_kB_kernel_nxw:
    s_cmp_eq_u32 s16, 0
    s_cbranch_scc0 L_kB_kernel_xn_pd
    s_lshl_b32 s17, s56, 7
    s_lshl_b32 s18, s57, 2
    s_add_u32 s17, s17, s18
    s_add_u32 s17, s17, 22332416
    v_mov_b32 v1, s17
    v_mov_b32 v2, 1
    s_mov_b64 exec, 1
    s_cmp_eq_u32 s58, 1
    s_cbranch_scc1 L_kB_kernel_xn_pure
    buffer_wbl2 sc1
    s_waitcnt vmcnt(0)
    buffer_store_dword v2, v1, s[40:43], 0 offen sc1
    s_branch L_kB_kernel_xn_pe
L_kB_kernel_xn_pure:
    buffer_store_dword v2, v1, s[40:43], 0 offen
L_kB_kernel_xn_pe:
    s_mov_b64 exec, -1
L_kB_kernel_xn_pd:
    s_cmp_eq_u32 s16, 0
    s_cbranch_scc0 L_kB_kernel_xnw_done
    s_mov_b32 s17, 0
L_kB_kernel_xnw_poll:
    buffer_load_dword v1, v11, s[40:43], 0 offen sc1
    s_waitcnt vmcnt(0)
    v_cmp_ne_u32 vcc, 1, v1
    s_nop 4
    s_cbranch_vccz L_kB_kernel_xnw_ok
    s_add_u32 s17, s17, 1
    s_cmp_lt_u32 s17, 400000
    s_cbranch_scc1 L_kB_kernel_xnw_poll
L_kB_kernel_xnw_ok:
    s_cmp_eq_u32 s58, 1
    s_cbranch_scc1 L_kB_kernel_xnw_done
    buffer_inv sc1
    s_waitcnt vmcnt(0)
L_kB_kernel_xnw_done:
    s_barrier
    s_cmp_ge_u32 s57, 28
    s_cbranch_scc1 L_kB_kernel_skip4
    s_add_u32 s27, s8, 0
    buffer_load_dwordx4 v[36:39], v6, s[40:43], s27 offen offset:0
    buffer_load_dwordx4 v[40:43], v6, s[40:43], s27 offen offset:1024
    buffer_load_dwordx4 v[44:47], v6, s[40:43], s27 offen offset:2048
    buffer_load_dwordx4 v[48:51], v6, s[40:43], s27 offen offset:3072
    s_add_u32 s27, s8, 4096
    buffer_load_dwordx4 v[52:55], v6, s[40:43], s27 offen offset:0
    buffer_load_dwordx4 v[56:59], v6, s[40:43], s27 offen offset:1024
    buffer_load_dwordx4 v[60:63], v6, s[40:43], s27 offen offset:2048
    buffer_load_dwordx4 v[64:67], v6, s[40:43], s27 offen offset:3072
    v_lshrrev_b32 v7, 5, v3
    v_bfe_u32 v8, v3, 2, 2
    v_lshl_add_u32 v7, v7, 2, v8
    v_lshlrev_b32 v253, 8, v7
    v_lshl_add_u32 v253, v8, 6, v253
    v_bfe_u32 v8, v3, 4, 1
    v_lshl_add_u32 v253, v8, 5, v253
    v_and_b32 v8, 3, v3
    v_lshl_add_u32 v253, v8, 3, v253
    v_mov_b32 v252, 0x3f317218
    s_mov_b32 s67, 0xbfb17218
    v_mov_b32 v16, v12
    s_nop 1
    v_mfma_f32_32x32x16_bf16 v[164:179], v[16:19], v[20:23], 0
    v_mov_b32 v16, v13
    s_nop 1
    v_mfma_f32_32x32x16_bf16 v[180:195], v[16:19], v[20:23], 0
    v_mov_b32 v16, v14
    s_nop 1
    v_mfma_f32_32x32x16_bf16 v[196:211], v[16:19], v[20:23], 0
    v_mov_b32 v16, v15
    s_nop 1
    v_mfma_f32_32x32x16_bf16 v[212:227], v[16:19], v[20:23], 0
    v_xor_b32 v12, 0, v253
    v_add_u32 v13, 0x10000, v12
    v_xor_b32 v14, 64, v253
    v_add_u32 v15, 0x10000, v14
    ds_read_b64_tr_b16 v[228:229], v12 offset:0
    ds_read_b64_tr_b16 v[230:231], v12 offset:4096
    ds_read_b64_tr_b16 v[232:233], v14 offset:0
    ds_read_b64_tr_b16 v[234:235], v14 offset:4096
    ds_read_b64_tr_b16 v[236:237], v12 offset:2048
    ds_read_b64_tr_b16 v[238:239], v12 offset:6144
    s_waitcnt vmcnt(7)
    s_waitcnt lgkmcnt(4)
    v_mfma_f32_32x32x16_bf16 v[164:179], v[228:231], v[36:39], v[164:179]
    ds_read_b64_tr_b16 v[240:241], v14 offset:2048
    ds_read_b64_tr_b16 v[242:243], v14 offset:6144
    s_waitcnt lgkmcnt(4)
    v_mfma_f32_32x32x16_bf16 v[180:195], v[232:235], v[36:39], v[180:195]
    ds_read_b64_tr_b16 v[228:229], v12 offset:8192
    ds_read_b64_tr_b16 v[230:231], v12 offset:12288
    s_add_u32 s27, s8, 8192
    buffer_load_dwordx4 v[68:71], v6, s[40:43], s27 offen offset:0
    s_waitcnt vmcnt(7)
    s_waitcnt lgkmcnt(4)
    v_mfma_f32_32x32x16_bf16 v[164:179], v[236:239], v[40:43], v[164:179]
    ds_read_b64_tr_b16 v[232:233], v14 offset:8192
    ds_read_b64_tr_b16 v[234:235], v14 offset:12288
    s_waitcnt lgkmcnt(4)
    v_mfma_f32_32x32x16_bf16 v[180:195], v[240:243], v[40:43], v[180:195]
    ds_read_b64_tr_b16 v[236:237], v12 offset:10240
    ds_read_b64_tr_b16 v[238:239], v12 offset:14336
    buffer_load_dwordx4 v[72:75], v6, s[40:43], s27 offen offset:1024
    s_waitcnt vmcnt(7)
    s_waitcnt lgkmcnt(4)
    v_mfma_f32_32x32x16_bf16 v[164:179], v[228:231], v[44:47], v[164:179]
    ds_read_b64_tr_b16 v[240:241], v14 offset:10240
    ds_read_b64_tr_b16 v[242:243], v14 offset:14336
    s_waitcnt lgkmcnt(4)
    v_mfma_f32_32x32x16_bf16 v[180:195], v[232:235], v[44:47], v[180:195]
    ds_read_b64_tr_b16 v[228:229], v12 offset:16384
    ds_read_b64_tr_b16 v[230:231], v12 offset:20480
    buffer_load_dwordx4 v[76:79], v6, s[40:43], s27 offen offset:2048
    s_waitcnt vmcnt(7)
    s_waitcnt lgkmcnt(4)
    v_mfma_f32_32x32x16_bf16 v[164:179], v[236:239], v[48:51], v[164:179]
    ds_read_b64_tr_b16 v[232:233], v14 offset:16384
    ds_read_b64_tr_b16 v[234:235], v14 offset:20480
    s_waitcnt lgkmcnt(4)
    v_mfma_f32_32x32x16_bf16 v[180:195], v[240:243], v[48:51], v[180:195]
    ds_read_b64_tr_b16 v[236:237], v12 offset:18432
    ds_read_b64_tr_b16 v[238:239], v12 offset:22528
    buffer_load_dwordx4 v[80:83], v6, s[40:43], s27 offen offset:3072
    s_waitcnt vmcnt(7)
    s_waitcnt lgkmcnt(4)
    v_mfma_f32_32x32x16_bf16 v[164:179], v[228:231], v[52:55], v[164:179]
    ds_read_b64_tr_b16 v[240:241], v14 offset:18432
    ds_read_b64_tr_b16 v[242:243], v14 offset:22528
    s_waitcnt lgkmcnt(4)
    v_mfma_f32_32x32x16_bf16 v[180:195], v[232:235], v[52:55], v[180:195]
    ds_read_b64_tr_b16 v[228:229], v12 offset:24576
    ds_read_b64_tr_b16 v[230:231], v12 offset:28672
    s_add_u32 s27, s8, 12288
    buffer_load_dwordx4 v[84:87], v6, s[40:43], s27 offen offset:0
    s_waitcnt vmcnt(7)
    s_waitcnt lgkmcnt(4)
    v_mfma_f32_32x32x16_bf16 v[164:179], v[236:239], v[56:59], v[164:179]
    ds_read_b64_tr_b16 v[232:233], v14 offset:24576
    ds_read_b64_tr_b16 v[234:235], v14 offset:28672
    s_waitcnt lgkmcnt(4)
    v_mfma_f32_32x32x16_bf16 v[180:195], v[240:243], v[56:59], v[180:195]
    ds_read_b64_tr_b16 v[236:237], v12 offset:26624
    ds_read_b64_tr_b16 v[238:239], v12 offset:30720
    buffer_load_dwordx4 v[88:91], v6, s[40:43], s27 offen offset:1024
    s_waitcnt vmcnt(7)
    s_waitcnt lgkmcnt(4)
    v_mfma_f32_32x32x16_bf16 v[164:179], v[228:231], v[60:63], v[164:179]
    ds_read_b64_tr_b16 v[240:241], v14 offset:26624
    ds_read_b64_tr_b16 v[242:243], v14 offset:30720
    s_waitcnt lgkmcnt(4)
    v_mfma_f32_32x32x16_bf16 v[180:195], v[232:235], v[60:63], v[180:195]
    ds_read_b64_tr_b16 v[228:229], v12 offset:32768
    ds_read_b64_tr_b16 v[230:231], v12 offset:36864
    buffer_load_dwordx4 v[92:95], v6, s[40:43], s27 offen offset:2048
    s_waitcnt vmcnt(7)
    s_waitcnt lgkmcnt(4)
    v_mfma_f32_32x32x16_bf16 v[164:179], v[236:239], v[64:67], v[164:179]
    ds_read_b64_tr_b16 v[232:233], v14 offset:32768
    ds_read_b64_tr_b16 v[234:235], v14 offset:36864
    s_waitcnt lgkmcnt(4)
    v_mfma_f32_32x32x16_bf16 v[180:195], v[240:243], v[64:67], v[180:195]
    ds_read_b64_tr_b16 v[236:237], v12 offset:34816
    ds_read_b64_tr_b16 v[238:239], v12 offset:38912
    buffer_load_dwordx4 v[96:99], v6, s[40:43], s27 offen offset:3072
    s_waitcnt vmcnt(7)
    s_waitcnt lgkmcnt(4)
    v_mfma_f32_32x32x16_bf16 v[164:179], v[228:231], v[68:71], v[164:179]
    ds_read_b64_tr_b16 v[240:241], v14 offset:34816
    ds_read_b64_tr_b16 v[242:243], v14 offset:38912
    s_waitcnt lgkmcnt(4)
    v_mfma_f32_32x32x16_bf16 v[180:195], v[232:235], v[68:71], v[180:195]
    ds_read_b64_tr_b16 v[228:229], v12 offset:40960
    ds_read_b64_tr_b16 v[230:231], v12 offset:45056
    s_add_u32 s27, s8, 16384
    buffer_load_dwordx4 v[100:103], v6, s[40:43], s27 offen offset:0
    s_waitcnt vmcnt(7)
    s_waitcnt lgkmcnt(4)
    v_mfma_f32_32x32x16_bf16 v[164:179], v[236:239], v[72:75], v[164:179]
    ds_read_b64_tr_b16 v[232:233], v14 offset:40960
    ds_read_b64_tr_b16 v[234:235], v14 offset:45056
    s_waitcnt lgkmcnt(4)
    v_mfma_f32_32x32x16_bf16 v[180:195], v[240:243], v[72:75], v[180:195]
    ds_read_b64_tr_b16 v[236:237], v12 offset:43008
    ds_read_b64_tr_b16 v[238:239], v12 offset:47104
    buffer_load_dwordx4 v[104:107], v6, s[40:43], s27 offen offset:1024
    s_waitcnt vmcnt(7)
    s_waitcnt lgkmcnt(4)
    v_mfma_f32_32x32x16_bf16 v[164:179], v[228:231], v[76:79], v[164:179]
    ds_read_b64_tr_b16 v[240:241], v14 offset:43008
    ds_read_b64_tr_b16 v[242:243], v14 offset:47104
    s_waitcnt lgkmcnt(4)
    v_mfma_f32_32x32x16_bf16 v[180:195], v[232:235], v[76:79], v[180:195]
    ds_read_b64_tr_b16 v[228:229], v12 offset:49152
    ds_read_b64_tr_b16 v[230:231], v12 offset:53248
    buffer_load_dwordx4 v[108:111], v6, s[40:43], s27 offen offset:2048
    s_waitcnt vmcnt(7)
    s_waitcnt lgkmcnt(4)
    v_mfma_f32_32x32x16_bf16 v[164:179], v[236:239], v[80:83], v[164:179]
    ds_read_b64_tr_b16 v[232:233], v14 offset:49152
    ds_read_b64_tr_b16 v[234:235], v14 offset:53248
    s_waitcnt lgkmcnt(4)
    v_mfma_f32_32x32x16_bf16 v[180:195], v[240:243], v[80:83], v[180:195]
    ds_read_b64_tr_b16 v[236:237], v12 offset:51200
    ds_read_b64_tr_b16 v[238:239], v12 offset:55296
    buffer_load_dwordx4 v[112:115], v6, s[40:43], s27 offen offset:3072
    s_waitcnt vmcnt(7)
    s_waitcnt lgkmcnt(4)
    v_mfma_f32_32x32x16_bf16 v[164:179], v[228:231], v[84:87], v[164:179]
    ds_read_b64_tr_b16 v[240:241], v14 offset:51200
    ds_read_b64_tr_b16 v[242:243], v14 offset:55296
    s_waitcnt lgkmcnt(4)
    v_mfma_f32_32x32x16_bf16 v[180:195], v[232:235], v[84:87], v[180:195]
    ds_read_b64_tr_b16 v[228:229], v12 offset:57344
    ds_read_b64_tr_b16 v[230:231], v12 offset:61440
    s_add_u32 s27, s8, 20480
    buffer_load_dwordx4 v[116:119], v6, s[40:43], s27 offen offset:0
    s_waitcnt vmcnt(7)
    s_waitcnt lgkmcnt(4)
    v_mfma_f32_32x32x16_bf16 v[164:179], v[236:239], v[88:91], v[164:179]
    ds_read_b64_tr_b16 v[232:233], v14 offset:57344
    ds_read_b64_tr_b16 v[234:235], v14 offset:61440
    s_waitcnt lgkmcnt(4)
    v_mfma_f32_32x32x16_bf16 v[180:195], v[240:243], v[88:91], v[180:195]
    ds_read_b64_tr_b16 v[236:237], v12 offset:59392
    ds_read_b64_tr_b16 v[238:239], v12 offset:63488
    buffer_load_dwordx4 v[120:123], v6, s[40:43], s27 offen offset:1024
    s_waitcnt vmcnt(7)
    s_waitcnt lgkmcnt(4)
    v_mfma_f32_32x32x16_bf16 v[164:179], v[228:231], v[92:95], v[164:179]
    ds_read_b64_tr_b16 v[240:241], v14 offset:59392
    ds_read_b64_tr_b16 v[242:243], v14 offset:63488
    s_waitcnt lgkmcnt(4)
    v_mfma_f32_32x32x16_bf16 v[180:195], v[232:235], v[92:95], v[180:195]
    ds_read_b64_tr_b16 v[228:229], v13 offset:0
    ds_read_b64_tr_b16 v[230:231], v13 offset:4096
    buffer_load_dwordx4 v[124:127], v6, s[40:43], s27 offen offset:2048
    s_waitcnt vmcnt(7)
    s_waitcnt lgkmcnt(4)
    v_mfma_f32_32x32x16_bf16 v[164:179], v[236:239], v[96:99], v[164:179]
    ds_read_b64_tr_b16 v[232:233], v15 offset:0
    ds_read_b64_tr_b16 v[234:235], v15 offset:4096
    s_waitcnt lgkmcnt(4)
    v_mfma_f32_32x32x16_bf16 v[180:195], v[240:243], v[96:99], v[180:195]
    ds_read_b64_tr_b16 v[236:237], v13 offset:2048
    ds_read_b64_tr_b16 v[238:239], v13 offset:6144
    buffer_load_dwordx4 v[128:131], v6, s[40:43], s27 offen offset:3072
    s_waitcnt vmcnt(7)
    s_waitcnt lgkmcnt(4)
    v_mfma_f32_32x32x16_bf16 v[164:179], v[228:231], v[100:103], v[164:179]
    ds_read_b64_tr_b16 v[240:241], v15 offset:2048
    ds_read_b64_tr_b16 v[242:243], v15 offset:6144
    s_waitcnt lgkmcnt(4)
    v_mfma_f32_32x32x16_bf16 v[180:195], v[232:235], v[100:103], v[180:195]
    ds_read_b64_tr_b16 v[228:229], v13 offset:8192
    ds_read_b64_tr_b16 v[230:231], v13 offset:12288
    s_add_u32 s27, s8, 24576
    buffer_load_dwordx4 v[132:135], v6, s[40:43], s27 offen offset:0
    s_waitcnt vmcnt(7)
    s_waitcnt lgkmcnt(4)
    v_mfma_f32_32x32x16_bf16 v[164:179], v[236:239], v[104:107], v[164:179]
    ds_read_b64_tr_b16 v[232:233], v15 offset:8192
    ds_read_b64_tr_b16 v[234:235], v15 offset:12288
    s_waitcnt lgkmcnt(4)
    v_mfma_f32_32x32x16_bf16 v[180:195], v[240:243], v[104:107], v[180:195]
    ds_read_b64_tr_b16 v[236:237], v13 offset:10240
    ds_read_b64_tr_b16 v[238:239], v13 offset:14336
    buffer_load_dwordx4 v[136:139], v6, s[40:43], s27 offen offset:1024
    s_waitcnt vmcnt(7)
    s_waitcnt lgkmcnt(4)
    v_mfma_f32_32x32x16_bf16 v[164:179], v[228:231], v[108:111], v[164:179]
    ds_read_b64_tr_b16 v[240:241], v15 offset:10240
    ds_read_b64_tr_b16 v[242:243], v15 offset:14336
    s_waitcnt lgkmcnt(4)
    v_mfma_f32_32x32x16_bf16 v[180:195], v[232:235], v[108:111], v[180:195]
    ds_read_b64_tr_b16 v[228:229], v13 offset:16384
    ds_read_b64_tr_b16 v[230:231], v13 offset:20480
    buffer_load_dwordx4 v[140:143], v6, s[40:43], s27 offen offset:2048
    s_waitcnt vmcnt(7)
    s_waitcnt lgkmcnt(4)
    v_mfma_f32_32x32x16_bf16 v[164:179], v[236:239], v[112:115], v[164:179]
    ds_read_b64_tr_b16 v[232:233], v15 offset:16384
    ds_read_b64_tr_b16 v[234:235], v15 offset:20480
    s_waitcnt lgkmcnt(4)
    v_mfma_f32_32x32x16_bf16 v[180:195], v[240:243], v[112:115], v[180:195]
    ds_read_b64_tr_b16 v[236:237], v13 offset:18432
    ds_read_b64_tr_b16 v[238:239], v13 offset:22528
    buffer_load_dwordx4 v[144:147], v6, s[40:43], s27 offen offset:3072
    s_waitcnt vmcnt(7)
    s_waitcnt lgkmcnt(4)
    v_mfma_f32_32x32x16_bf16 v[164:179], v[228:231], v[116:119], v[164:179]
    ds_read_b64_tr_b16 v[240:241], v15 offset:18432
    ds_read_b64_tr_b16 v[242:243], v15 offset:22528
    s_waitcnt lgkmcnt(4)
    v_mfma_f32_32x32x16_bf16 v[180:195], v[232:235], v[116:119], v[180:195]
    ds_read_b64_tr_b16 v[228:229], v13 offset:24576
    ds_read_b64_tr_b16 v[230:231], v13 offset:28672
    s_add_u32 s27, s8, 28672
    buffer_load_dwordx4 v[148:151], v6, s[40:43], s27 offen offset:0
    s_waitcnt vmcnt(7)
    s_waitcnt lgkmcnt(4)
    v_mfma_f32_32x32x16_bf16 v[164:179], v[236:239], v[120:123], v[164:179]
    ds_read_b64_tr_b16 v[232:233], v15 offset:24576
    ds_read_b64_tr_b16 v[234:235], v15 offset:28672
    s_waitcnt lgkmcnt(4)
    v_mfma_f32_32x32x16_bf16 v[180:195], v[240:243], v[120:123], v[180:195]
    ds_read_b64_tr_b16 v[236:237], v13 offset:26624
    ds_read_b64_tr_b16 v[238:239], v13 offset:30720
    buffer_load_dwordx4 v[152:155], v6, s[40:43], s27 offen offset:1024
    s_waitcnt vmcnt(7)
    s_waitcnt lgkmcnt(4)
    v_mfma_f32_32x32x16_bf16 v[164:179], v[228:231], v[124:127], v[164:179]
    ds_read_b64_tr_b16 v[240:241], v15 offset:26624
    ds_read_b64_tr_b16 v[242:243], v15 offset:30720
    s_waitcnt lgkmcnt(4)
    v_mfma_f32_32x32x16_bf16 v[180:195], v[232:235], v[124:127], v[180:195]
    ds_read_b64_tr_b16 v[228:229], v13 offset:32768
    ds_read_b64_tr_b16 v[230:231], v13 offset:36864
    buffer_load_dwordx4 v[156:159], v6, s[40:43], s27 offen offset:2048
    s_waitcnt vmcnt(7)
    s_waitcnt lgkmcnt(4)
    v_mfma_f32_32x32x16_bf16 v[164:179], v[236:239], v[128:131], v[164:179]
    ds_read_b64_tr_b16 v[232:233], v15 offset:32768
    ds_read_b64_tr_b16 v[234:235], v15 offset:36864
    s_waitcnt lgkmcnt(4)
    v_mfma_f32_32x32x16_bf16 v[180:195], v[240:243], v[128:131], v[180:195]
    ds_read_b64_tr_b16 v[236:237], v13 offset:34816
    ds_read_b64_tr_b16 v[238:239], v13 offset:38912
    buffer_load_dwordx4 v[160:163], v6, s[40:43], s27 offen offset:3072
    s_waitcnt vmcnt(7)
    s_waitcnt lgkmcnt(4)
    v_mfma_f32_32x32x16_bf16 v[164:179], v[228:231], v[132:135], v[164:179]
    ds_read_b64_tr_b16 v[240:241], v15 offset:34816
    ds_read_b64_tr_b16 v[242:243], v15 offset:38912
    s_waitcnt lgkmcnt(4)
    v_mfma_f32_32x32x16_bf16 v[180:195], v[232:235], v[132:135], v[180:195]
    ds_read_b64_tr_b16 v[228:229], v13 offset:40960
    ds_read_b64_tr_b16 v[230:231], v13 offset:45056
    s_add_u32 s65, s63, 8192
    buffer_load_dwordx4 a[64:67], v6, s[40:43], s65 offen offset:0
    s_waitcnt vmcnt(7)
    s_waitcnt lgkmcnt(4)
    v_mfma_f32_32x32x16_bf16 v[164:179], v[236:239], v[136:139], v[164:179]
    ds_read_b64_tr_b16 v[232:233], v15 offset:40960
    ds_read_b64_tr_b16 v[234:235], v15 offset:45056
    s_waitcnt lgkmcnt(4)
    v_mfma_f32_32x32x16_bf16 v[180:195], v[240:243], v[136:139], v[180:195]
    ds_read_b64_tr_b16 v[236:237], v13 offset:43008
    ds_read_b64_tr_b16 v[238:239], v13 offset:47104
    buffer_load_dwordx4 a[72:75], v6, s[40:43], s65 offen offset:1024
    s_waitcnt vmcnt(7)
    s_waitcnt lgkmcnt(4)
    v_mfma_f32_32x32x16_bf16 v[164:179], v[228:231], v[140:143], v[164:179]
    ds_read_b64_tr_b16 v[240:241], v15 offset:43008
    ds_read_b64_tr_b16 v[242:243], v15 offset:47104
    s_waitcnt lgkmcnt(4)
    v_mfma_f32_32x32x16_bf16 v[180:195], v[232:235], v[140:143], v[180:195]
    ds_read_b64_tr_b16 v[228:229], v13 offset:49152
    ds_read_b64_tr_b16 v[230:231], v13 offset:53248
    buffer_load_dwordx4 a[80:83], v6, s[40:43], s65 offen offset:2048
    s_waitcnt vmcnt(7)
    s_waitcnt lgkmcnt(4)
    v_mfma_f32_32x32x16_bf16 v[164:179], v[236:239], v[144:147], v[164:179]
    ds_read_b64_tr_b16 v[232:233], v15 offset:49152
    ds_read_b64_tr_b16 v[234:235], v15 offset:53248
    s_waitcnt lgkmcnt(4)
    v_mfma_f32_32x32x16_bf16 v[180:195], v[240:243], v[144:147], v[180:195]
    ds_read_b64_tr_b16 v[236:237], v13 offset:51200
    ds_read_b64_tr_b16 v[238:239], v13 offset:55296
    buffer_load_dwordx4 a[88:91], v6, s[40:43], s65 offen offset:3072
    s_waitcnt vmcnt(7)
    s_waitcnt lgkmcnt(4)
    v_mfma_f32_32x32x16_bf16 v[164:179], v[228:231], v[148:151], v[164:179]
    ds_read_b64_tr_b16 v[240:241], v15 offset:51200
    ds_read_b64_tr_b16 v[242:243], v15 offset:55296
    s_waitcnt lgkmcnt(4)
    v_mfma_f32_32x32x16_bf16 v[180:195], v[232:235], v[148:151], v[180:195]
    ds_read_b64_tr_b16 v[228:229], v13 offset:57344
    ds_read_b64_tr_b16 v[230:231], v13 offset:61440
    s_add_u32 s66, s64, 8192
    buffer_load_dwordx4 a[68:71], v6, s[40:43], s66 offen offset:0
    s_waitcnt vmcnt(7)
    s_waitcnt lgkmcnt(4)
    v_mfma_f32_32x32x16_bf16 v[164:179], v[236:239], v[152:155], v[164:179]
    ds_read_b64_tr_b16 v[232:233], v15 offset:57344
    ds_read_b64_tr_b16 v[234:235], v15 offset:61440
    s_waitcnt lgkmcnt(4)
    v_mfma_f32_32x32x16_bf16 v[180:195], v[240:243], v[152:155], v[180:195]
    ds_read_b64_tr_b16 v[236:237], v13 offset:59392
    ds_read_b64_tr_b16 v[238:239], v13 offset:63488
    buffer_load_dwordx4 a[76:79], v6, s[40:43], s66 offen offset:1024
    s_waitcnt vmcnt(7)
    s_waitcnt lgkmcnt(4)
    v_mfma_f32_32x32x16_bf16 v[164:179], v[228:231], v[156:159], v[164:179]
    ds_read_b64_tr_b16 v[240:241], v15 offset:59392
    ds_read_b64_tr_b16 v[242:243], v15 offset:63488
    s_waitcnt lgkmcnt(4)
    v_mfma_f32_32x32x16_bf16 v[180:195], v[232:235], v[156:159], v[180:195]
    buffer_load_dwordx4 a[84:87], v6, s[40:43], s66 offen offset:2048
    s_waitcnt vmcnt(7)
    s_waitcnt lgkmcnt(2)
    v_mfma_f32_32x32x16_bf16 v[164:179], v[236:239], v[160:163], v[164:179]
    s_waitcnt lgkmcnt(0)
    v_mfma_f32_32x32x16_bf16 v[180:195], v[240:243], v[160:163], v[180:195]
    buffer_load_dwordx4 a[92:95], v6, s[40:43], s66 offen offset:3072
    v_xor_b32 v12, 128, v253
    v_add_u32 v13, 0x10000, v12
    v_xor_b32 v14, 192, v253
    v_add_u32 v15, 0x10000, v14
    ds_read_b64_tr_b16 v[228:229], v12 offset:0
    ds_read_b64_tr_b16 v[230:231], v12 offset:4096
    ds_read_b64_tr_b16 v[232:233], v14 offset:0
    ds_read_b64_tr_b16 v[234:235], v14 offset:4096
    ds_read_b64_tr_b16 v[236:237], v12 offset:2048
    ds_read_b64_tr_b16 v[238:239], v12 offset:6144
    s_waitcnt lgkmcnt(4)
    v_mfma_f32_32x32x16_bf16 v[196:211], v[228:231], v[36:39], v[196:211]
    ds_read_b64_tr_b16 v[240:241], v14 offset:2048
    ds_read_b64_tr_b16 v[242:243], v14 offset:6144
    s_add_u32 s65, s63, 12288
    buffer_load_dwordx4 a[96:99], v6, s[40:43], s65 offen offset:0
    s_waitcnt lgkmcnt(4)
    v_mfma_f32_32x32x16_bf16 v[212:227], v[232:235], v[36:39], v[212:227]
    ds_read_b64_tr_b16 v[228:229], v12 offset:8192
    ds_read_b64_tr_b16 v[230:231], v12 offset:12288
    s_waitcnt lgkmcnt(4)
    v_mfma_f32_32x32x16_bf16 v[196:211], v[236:239], v[40:43], v[196:211]
    ds_read_b64_tr_b16 v[232:233], v14 offset:8192
    ds_read_b64_tr_b16 v[234:235], v14 offset:12288
    buffer_load_dwordx4 a[104:107], v6, s[40:43], s65 offen offset:1024
    v_exp_f32 v24, v164
    v_exp_f32 v25, v165
    s_waitcnt lgkmcnt(4)
    v_mfma_f32_32x32x16_bf16 v[212:227], v[240:243], v[40:43], v[212:227]
    ds_read_b64_tr_b16 v[236:237], v12 offset:10240
    ds_read_b64_tr_b16 v[238:239], v12 offset:14336
    v_exp_f32 v26, v166
    v_add_f32 v24, 1.0, v24
    v_exp_f32 v27, v167
    s_waitcnt lgkmcnt(4)
    v_mfma_f32_32x32x16_bf16 v[196:211], v[228:231], v[44:47], v[196:211]
    ds_read_b64_tr_b16 v[240:241], v14 offset:10240
    ds_read_b64_tr_b16 v[242:243], v14 offset:14336
    buffer_load_dwordx4 a[112:115], v6, s[40:43], s65 offen offset:2048
    v_add_f32 v25, 1.0, v25
    v_exp_f32 v28, v168
    v_add_f32 v26, 1.0, v26
    v_fma_f32 v24, v24, v24, 1.0
    s_waitcnt lgkmcnt(4)
    v_mfma_f32_32x32x16_bf16 v[212:227], v[232:235], v[44:47], v[212:227]
    ds_read_b64_tr_b16 v[228:229], v12 offset:16384
    ds_read_b64_tr_b16 v[230:231], v12 offset:20480
    v_exp_f32 v29, v169
    v_add_f32 v27, 1.0, v27
    v_fma_f32 v25, v25, v25, 1.0
    s_waitcnt lgkmcnt(4)
    v_mfma_f32_32x32x16_bf16 v[196:211], v[236:239], v[48:51], v[196:211]
    ds_read_b64_tr_b16 v[232:233], v14 offset:16384
    ds_read_b64_tr_b16 v[234:235], v14 offset:20480
    buffer_load_dwordx4 a[120:123], v6, s[40:43], s65 offen offset:3072
    v_exp_f32 v30, v170
    v_add_f32 v28, 1.0, v28
    v_fma_f32 v26, v26, v26, 1.0
    s_waitcnt lgkmcnt(4)
    v_mfma_f32_32x32x16_bf16 v[212:227], v[240:243], v[48:51], v[212:227]
    ds_read_b64_tr_b16 v[236:237], v12 offset:18432
    ds_read_b64_tr_b16 v[238:239], v12 offset:22528
    s_add_u32 s66, s64, 12288
    buffer_load_dwordx4 a[100:103], v6, s[40:43], s66 offen offset:0
    v_rcp_f32 v24, v24
    v_exp_f32 v31, v171
    v_add_f32 v29, 1.0, v29
    s_waitcnt lgkmcnt(4)
    v_mfma_f32_32x32x16_bf16 v[196:211], v[228:231], v[52:55], v[196:211]
    ds_read_b64_tr_b16 v[240:241], v14 offset:18432
    ds_read_b64_tr_b16 v[242:243], v14 offset:22528
    v_fma_f32 v27, v27, v27, 1.0
    v_rcp_f32 v25, v25
    v_add_f32 v30, 1.0, v30
    v_fma_f32 v28, v28, v28, 1.0
    s_waitcnt lgkmcnt(4)
    v_mfma_f32_32x32x16_bf16 v[212:227], v[232:235], v[52:55], v[212:227]
    ds_read_b64_tr_b16 v[228:229], v12 offset:24576
    ds_read_b64_tr_b16 v[230:231], v12 offset:28672
    buffer_load_dwordx4 a[108:111], v6, s[40:43], s66 offen offset:1024
    v_rcp_f32 v26, v26
    v_fma_f32 v24, v24, s67, v252
    v_add_f32 v31, 1.0, v31
    s_waitcnt lgkmcnt(4)
    v_mfma_f32_32x32x16_bf16 v[196:211], v[236:239], v[56:59], v[196:211]
    ds_read_b64_tr_b16 v[232:233], v14 offset:24576
    ds_read_b64_tr_b16 v[234:235], v14 offset:28672
    v_fma_f32 v29, v29, v29, 1.0
    v_rcp_f32 v27, v27
    v_fma_f32 v25, v25, s67, v252
    v_fma_f32 v30, v30, v30, 1.0
    s_waitcnt lgkmcnt(4)
    v_mfma_f32_32x32x16_bf16 v[212:227], v[240:243], v[56:59], v[212:227]
    ds_read_b64_tr_b16 v[236:237], v12 offset:26624
    ds_read_b64_tr_b16 v[238:239], v12 offset:30720
    buffer_load_dwordx4 a[116:119], v6, s[40:43], s66 offen offset:2048
    v_rcp_f32 v28, v28
    v_fma_f32 v26, v26, s67, v252
    v_mul_f32 v24, v164, v24
    s_waitcnt lgkmcnt(4)
    v_mfma_f32_32x32x16_bf16 v[196:211], v[228:231], v[60:63], v[196:211]
    ds_read_b64_tr_b16 v[240:241], v14 offset:26624
    ds_read_b64_tr_b16 v[242:243], v14 offset:30720
    v_fma_f32 v31, v31, v31, 1.0
    v_rcp_f32 v29, v29
    v_fma_f32 v27, v27, s67, v252
    v_mul_f32 v25, v165, v25
    s_waitcnt lgkmcnt(4)
    v_mfma_f32_32x32x16_bf16 v[212:227], v[232:235], v[60:63], v[212:227]
    ds_read_b64_tr_b16 v[228:229], v12 offset:32768
    ds_read_b64_tr_b16 v[230:231], v12 offset:36864
    buffer_load_dwordx4 a[124:127], v6, s[40:43], s66 offen offset:3072
    v_rcp_f32 v30, v30
    v_fma_f32 v28, v28, s67, v252
    v_mul_f32 v26, v166, v26
    s_waitcnt lgkmcnt(4)
    v_mfma_f32_32x32x16_bf16 v[196:211], v[236:239], v[64:67], v[196:211]
    ds_read_b64_tr_b16 v[232:233], v14 offset:32768
    ds_read_b64_tr_b16 v[234:235], v14 offset:36864
    s_add_u32 s65, s63, 16384
    buffer_load_dwordx4 a[128:131], v6, s[40:43], s65 offen offset:0
    v_rcp_f32 v31, v31
    v_fma_f32 v29, v29, s67, v252
    v_mul_f32 v27, v167, v27
    v_fma_f32 v30, v30, s67, v252
    s_waitcnt lgkmcnt(4)
    v_mfma_f32_32x32x16_bf16 v[212:227], v[240:243], v[64:67], v[212:227]
    ds_read_b64_tr_b16 v[236:237], v12 offset:34816
    ds_read_b64_tr_b16 v[238:239], v12 offset:38912
    v_mul_f32 v28, v168, v28
    v_fma_f32 v31, v31, s67, v252
    v_mul_f32 v29, v169, v29
    v_mul_f32 v30, v170, v30
    s_waitcnt lgkmcnt(4)
    v_mfma_f32_32x32x16_bf16 v[196:211], v[228:231], v[68:71], v[196:211]
    ds_read_b64_tr_b16 v[240:241], v14 offset:34816
    ds_read_b64_tr_b16 v[242:243], v14 offset:38912
    buffer_load_dwordx4 a[136:139], v6, s[40:43], s65 offen offset:1024
    v_mul_f32 v31, v171, v31
    v_cvt_pk_bf16_f32 v244, v24, v25
    v_cvt_pk_bf16_f32 v245, v26, v27
    v_cvt_pk_bf16_f32 v246, v28, v29
    v_cvt_pk_bf16_f32 v247, v30, v31
    s_waitcnt lgkmcnt(4)
    v_mfma_f32_32x32x16_bf16 v[212:227], v[232:235], v[68:71], v[212:227]
    ds_read_b64_tr_b16 v[228:229], v12 offset:40960
    ds_read_b64_tr_b16 v[230:231], v12 offset:45056
    buffer_store_dwordx4 v[244:247], v6, s[40:43], s4 offen sc1
    v_exp_f32 v24, v172
    v_exp_f32 v25, v173
    s_waitcnt lgkmcnt(4)
    v_mfma_f32_32x32x16_bf16 v[196:211], v[236:239], v[72:75], v[196:211]
    ds_read_b64_tr_b16 v[232:233], v14 offset:40960
    ds_read_b64_tr_b16 v[234:235], v14 offset:45056
    buffer_load_dwordx4 a[144:147], v6, s[40:43], s65 offen offset:2048
    v_exp_f32 v26, v174
    v_add_f32 v24, 1.0, v24
    s_waitcnt lgkmcnt(4)
    v_mfma_f32_32x32x16_bf16 v[212:227], v[240:243], v[72:75], v[212:227]
    ds_read_b64_tr_b16 v[236:237], v12 offset:43008
    ds_read_b64_tr_b16 v[238:239], v12 offset:47104
    v_exp_f32 v27, v175
    v_add_f32 v25, 1.0, v25
    v_exp_f32 v28, v176
    s_waitcnt lgkmcnt(4)
    v_mfma_f32_32x32x16_bf16 v[196:211], v[228:231], v[76:79], v[196:211]
    ds_read_b64_tr_b16 v[240:241], v14 offset:43008
    ds_read_b64_tr_b16 v[242:243], v14 offset:47104
    buffer_load_dwordx4 a[152:155], v6, s[40:43], s65 offen offset:3072
    v_add_f32 v26, 1.0, v26
    v_fma_f32 v24, v24, v24, 1.0
    v_exp_f32 v29, v177
    v_add_f32 v27, 1.0, v27
    s_waitcnt lgkmcnt(4)
    v_mfma_f32_32x32x16_bf16 v[212:227], v[232:235], v[76:79], v[212:227]
    ds_read_b64_tr_b16 v[228:229], v12 offset:49152
    ds_read_b64_tr_b16 v[230:231], v12 offset:53248
    s_add_u32 s66, s64, 16384
    buffer_load_dwordx4 a[132:135], v6, s[40:43], s66 offen offset:0
    v_fma_f32 v25, v25, v25, 1.0
    v_exp_f32 v30, v178
    v_add_f32 v28, 1.0, v28
    s_waitcnt lgkmcnt(4)
    v_mfma_f32_32x32x16_bf16 v[196:211], v[236:239], v[80:83], v[196:211]
    ds_read_b64_tr_b16 v[232:233], v14 offset:49152
    ds_read_b64_tr_b16 v[234:235], v14 offset:53248
    v_fma_f32 v26, v26, v26, 1.0
    v_rcp_f32 v24, v24
    v_exp_f32 v31, v179
    s_waitcnt lgkmcnt(4)
    v_mfma_f32_32x32x16_bf16 v[212:227], v[240:243], v[80:83], v[212:227]
    ds_read_b64_tr_b16 v[236:237], v12 offset:51200
    ds_read_b64_tr_b16 v[238:239], v12 offset:55296
    buffer_load_dwordx4 a[140:143], v6, s[40:43], s66 offen offset:1024
    v_add_f32 v29, 1.0, v29
    v_fma_f32 v27, v27, v27, 1.0
    v_rcp_f32 v25, v25
    v_add_f32 v30, 1.0, v30
    s_waitcnt lgkmcnt(4)
    v_mfma_f32_32x32x16_bf16 v[196:211], v[228:231], v[84:87], v[196:211]
    ds_read_b64_tr_b16 v[240:241], v14 offset:51200
    ds_read_b64_tr_b16 v[242:243], v14 offset:55296
    v_fma_f32 v28, v28, v28, 1.0
    v_rcp_f32 v26, v26
    v_fma_f32 v24, v24, s67, v252
    s_waitcnt lgkmcnt(4)
    v_mfma_f32_32x32x16_bf16 v[212:227], v[232:235], v[84:87], v[212:227]
    ds_read_b64_tr_b16 v[228:229], v12 offset:57344
    ds_read_b64_tr_b16 v[230:231], v12 offset:61440
    buffer_load_dwordx4 a[148:151], v6, s[40:43], s66 offen offset:2048
    v_add_f32 v31, 1.0, v31
    v_fma_f32 v29, v29, v29, 1.0
    v_rcp_f32 v27, v27
    v_fma_f32 v25, v25, s67, v252
    s_waitcnt lgkmcnt(4)
    v_mfma_f32_32x32x16_bf16 v[196:211], v[236:239], v[88:91], v[196:211]
    ds_read_b64_tr_b16 v[232:233], v14 offset:57344
    ds_read_b64_tr_b16 v[234:235], v14 offset:61440
    v_fma_f32 v30, v30, v30, 1.0
    v_rcp_f32 v28, v28
    v_fma_f32 v26, v26, s67, v252
    s_waitcnt lgkmcnt(4)
    v_mfma_f32_32x32x16_bf16 v[212:227], v[240:243], v[88:91], v[212:227]
    ds_read_b64_tr_b16 v[236:237], v12 offset:59392
    ds_read_b64_tr_b16 v[238:239], v12 offset:63488
    buffer_load_dwordx4 a[156:159], v6, s[40:43], s66 offen offset:3072
    v_mul_f32 v24, v172, v24
    v_fma_f32 v31, v31, v31, 1.0
    v_rcp_f32 v29, v29
    v_fma_f32 v27, v27, s67, v252
    s_waitcnt lgkmcnt(4)
    v_mfma_f32_32x32x16_bf16 v[196:211], v[228:231], v[92:95], v[196:211]
    ds_read_b64_tr_b16 v[240:241], v14 offset:59392
    ds_read_b64_tr_b16 v[242:243], v14 offset:63488
    s_add_u32 s65, s63, 20480
    buffer_load_dwordx4 a[160:163], v6, s[40:43], s65 offen offset:0
    v_mul_f32 v25, v173, v25
    v_rcp_f32 v30, v30
    v_fma_f32 v28, v28, s67, v252
    s_waitcnt lgkmcnt(4)
    v_mfma_f32_32x32x16_bf16 v[212:227], v[232:235], v[92:95], v[212:227]
    ds_read_b64_tr_b16 v[228:229], v13 offset:0
    ds_read_b64_tr_b16 v[230:231], v13 offset:4096
    v_mul_f32 v26, v174, v26
    v_rcp_f32 v31, v31
    v_fma_f32 v29, v29, s67, v252
    v_mul_f32 v27, v175, v27
    s_waitcnt lgkmcnt(4)
    v_mfma_f32_32x32x16_bf16 v[196:211], v[236:239], v[96:99], v[196:211]
    ds_read_b64_tr_b16 v[232:233], v15 offset:0
    ds_read_b64_tr_b16 v[234:235], v15 offset:4096
    buffer_load_dwordx4 a[168:171], v6, s[40:43], s65 offen offset:1024
    v_fma_f32 v30, v30, s67, v252
    v_mul_f32 v28, v176, v28
    v_fma_f32 v31, v31, s67, v252
    v_mul_f32 v29, v177, v29
    s_waitcnt lgkmcnt(4)
    v_mfma_f32_32x32x16_bf16 v[212:227], v[240:243], v[96:99], v[212:227]
    ds_read_b64_tr_b16 v[236:237], v13 offset:2048
    ds_read_b64_tr_b16 v[238:239], v13 offset:6144
    v_mul_f32 v30, v178, v30
    v_mul_f32 v31, v179, v31
    v_cvt_pk_bf16_f32 v248, v24, v25
    v_cvt_pk_bf16_f32 v249, v26, v27
    v_cvt_pk_bf16_f32 v250, v28, v29
    s_waitcnt lgkmcnt(4)
    v_mfma_f32_32x32x16_bf16 v[196:211], v[228:231], v[100:103], v[196:211]
    ds_read_b64_tr_b16 v[240:241], v15 offset:2048
    ds_read_b64_tr_b16 v[242:243], v15 offset:6144
    buffer_load_dwordx4 a[176:179], v6, s[40:43], s65 offen offset:2048
    v_cvt_pk_bf16_f32 v251, v30, v31
    buffer_store_dwordx4 v[248:251], v6, s[40:43], s4 offen offset:1024 sc1
    v_exp_f32 v24, v180
    s_waitcnt lgkmcnt(4)
    v_mfma_f32_32x32x16_bf16 v[212:227], v[232:235], v[100:103], v[212:227]
    ds_read_b64_tr_b16 v[228:229], v13 offset:8192
    ds_read_b64_tr_b16 v[230:231], v13 offset:12288
    v_exp_f32 v25, v181
    v_exp_f32 v26, v182
    v_add_f32 v24, 1.0, v24
    s_waitcnt lgkmcnt(4)
    v_mfma_f32_32x32x16_bf16 v[196:211], v[236:239], v[104:107], v[196:211]
    ds_read_b64_tr_b16 v[232:233], v15 offset:8192
    ds_read_b64_tr_b16 v[234:235], v15 offset:12288
    buffer_load_dwordx4 a[184:187], v6, s[40:43], s65 offen offset:3072
    v_exp_f32 v27, v183
    v_add_f32 v25, 1.0, v25
    v_exp_f32 v28, v184
    s_waitcnt lgkmcnt(4)
    v_mfma_f32_32x32x16_bf16 v[212:227], v[240:243], v[104:107], v[212:227]
    ds_read_b64_tr_b16 v[236:237], v13 offset:10240
    ds_read_b64_tr_b16 v[238:239], v13 offset:14336
    s_add_u32 s66, s64, 20480
    buffer_load_dwordx4 a[164:167], v6, s[40:43], s66 offen offset:0
    v_add_f32 v26, 1.0, v26
    v_fma_f32 v24, v24, v24, 1.0
    v_exp_f32 v29, v185
    s_waitcnt lgkmcnt(4)
    v_mfma_f32_32x32x16_bf16 v[196:211], v[228:231], v[108:111], v[196:211]
    ds_read_b64_tr_b16 v[240:241], v15 offset:10240
    ds_read_b64_tr_b16 v[242:243], v15 offset:14336
    v_add_f32 v27, 1.0, v27
    v_fma_f32 v25, v25, v25, 1.0
    v_exp_f32 v30, v186
    s_waitcnt lgkmcnt(4)
    v_mfma_f32_32x32x16_bf16 v[212:227], v[232:235], v[108:111], v[212:227]
    ds_read_b64_tr_b16 v[228:229], v13 offset:16384
    ds_read_b64_tr_b16 v[230:231], v13 offset:20480
    buffer_load_dwordx4 a[172:175], v6, s[40:43], s66 offen offset:1024
    v_add_f32 v28, 1.0, v28
    v_fma_f32 v26, v26, v26, 1.0
    v_rcp_f32 v24, v24
    s_waitcnt lgkmcnt(4)
    v_mfma_f32_32x32x16_bf16 v[196:211], v[236:239], v[112:115], v[196:211]
    ds_read_b64_tr_b16 v[232:233], v15 offset:16384
    ds_read_b64_tr_b16 v[234:235], v15 offset:20480
    v_exp_f32 v31, v187
    v_add_f32 v29, 1.0, v29
    v_fma_f32 v27, v27, v27, 1.0
    v_rcp_f32 v25, v25
    s_waitcnt lgkmcnt(4)
    v_mfma_f32_32x32x16_bf16 v[212:227], v[240:243], v[112:115], v[212:227]
    ds_read_b64_tr_b16 v[236:237], v13 offset:18432
    ds_read_b64_tr_b16 v[238:239], v13 offset:22528
    buffer_load_dwordx4 a[180:183], v6, s[40:43], s66 offen offset:2048
    v_add_f32 v30, 1.0, v30
    v_fma_f32 v28, v28, v28, 1.0
    v_rcp_f32 v26, v26
    s_waitcnt lgkmcnt(4)
    v_mfma_f32_32x32x16_bf16 v[196:211], v[228:231], v[116:119], v[196:211]
    ds_read_b64_tr_b16 v[240:241], v15 offset:18432
    ds_read_b64_tr_b16 v[242:243], v15 offset:22528
    v_fma_f32 v24, v24, s67, v252
    v_add_f32 v31, 1.0, v31
    v_fma_f32 v29, v29, v29, 1.0
    v_rcp_f32 v27, v27
    s_waitcnt lgkmcnt(4)
    v_mfma_f32_32x32x16_bf16 v[212:227], v[232:235], v[116:119], v[212:227]
    ds_read_b64_tr_b16 v[228:229], v13 offset:24576
    ds_read_b64_tr_b16 v[230:231], v13 offset:28672
    buffer_load_dwordx4 a[188:191], v6, s[40:43], s66 offen offset:3072
    v_fma_f32 v25, v25, s67, v252
    v_fma_f32 v30, v30, v30, 1.0
    v_rcp_f32 v28, v28
    s_waitcnt lgkmcnt(4)
    v_mfma_f32_32x32x16_bf16 v[196:211], v[236:239], v[120:123], v[196:211]
    ds_read_b64_tr_b16 v[232:233], v15 offset:24576
    ds_read_b64_tr_b16 v[234:235], v15 offset:28672
    s_add_u32 s65, s63, 24576
    buffer_load_dwordx4 a[192:195], v6, s[40:43], s65 offen offset:0
    v_fma_f32 v26, v26, s67, v252
    v_mul_f32 v24, v180, v24
    v_fma_f32 v31, v31, v31, 1.0
    v_rcp_f32 v29, v29
    s_waitcnt lgkmcnt(4)
    v_mfma_f32_32x32x16_bf16 v[212:227], v[240:243], v[120:123], v[212:227]
    ds_read_b64_tr_b16 v[236:237], v13 offset:26624
    ds_read_b64_tr_b16 v[238:239], v13 offset:30720
    v_fma_f32 v27, v27, s67, v252
    v_mul_f32 v25, v181, v25
    v_rcp_f32 v30, v30
    s_waitcnt lgkmcnt(4)
    v_mfma_f32_32x32x16_bf16 v[196:211], v[228:231], v[124:127], v[196:211]
    ds_read_b64_tr_b16 v[240:241], v15 offset:26624
    ds_read_b64_tr_b16 v[242:243], v15 offset:30720
    buffer_load_dwordx4 a[200:203], v6, s[40:43], s65 offen offset:1024
    v_fma_f32 v28, v28, s67, v252
    v_mul_f32 v26, v182, v26
    v_rcp_f32 v31, v31
    v_fma_f32 v29, v29, s67, v252
    s_waitcnt lgkmcnt(4)
    v_mfma_f32_32x32x16_bf16 v[212:227], v[232:235], v[124:127], v[212:227]
    ds_read_b64_tr_b16 v[228:229], v13 offset:32768
    ds_read_b64_tr_b16 v[230:231], v13 offset:36864
    v_mul_f32 v27, v183, v27
    v_fma_f32 v30, v30, s67, v252
    v_mul_f32 v28, v184, v28
    v_fma_f32 v31, v31, s67, v252
    s_waitcnt lgkmcnt(4)
    v_mfma_f32_32x32x16_bf16 v[196:211], v[236:239], v[128:131], v[196:211]
    ds_read_b64_tr_b16 v[232:233], v15 offset:32768
    ds_read_b64_tr_b16 v[234:235], v15 offset:36864
    buffer_load_dwordx4 a[208:211], v6, s[40:43], s65 offen offset:2048
    v_mul_f32 v29, v185, v29
    v_mul_f32 v30, v186, v30
    v_mul_f32 v31, v187, v31
    v_cvt_pk_bf16_f32 v244, v24, v25
    v_cvt_pk_bf16_f32 v245, v26, v27
    s_waitcnt lgkmcnt(4)
    v_mfma_f32_32x32x16_bf16 v[212:227], v[240:243], v[128:131], v[212:227]
    ds_read_b64_tr_b16 v[236:237], v13 offset:34816
    ds_read_b64_tr_b16 v[238:239], v13 offset:38912
    v_cvt_pk_bf16_f32 v246, v28, v29
    v_cvt_pk_bf16_f32 v247, v30, v31
    buffer_store_dwordx4 v[244:247], v6, s[40:43], s5 offen sc1
    v_exp_f32 v24, v188
    s_waitcnt lgkmcnt(4)
    v_mfma_f32_32x32x16_bf16 v[196:211], v[228:231], v[132:135], v[196:211]
    ds_read_b64_tr_b16 v[240:241], v15 offset:34816
    ds_read_b64_tr_b16 v[242:243], v15 offset:38912
    buffer_load_dwordx4 a[216:219], v6, s[40:43], s65 offen offset:3072
    v_exp_f32 v25, v189
    v_exp_f32 v26, v190
    s_waitcnt lgkmcnt(4)
    v_mfma_f32_32x32x16_bf16 v[212:227], v[232:235], v[132:135], v[212:227]
    ds_read_b64_tr_b16 v[228:229], v13 offset:40960
    ds_read_b64_tr_b16 v[230:231], v13 offset:45056
    s_add_u32 s66, s64, 24576
    buffer_load_dwordx4 a[196:199], v6, s[40:43], s66 offen offset:0
    v_add_f32 v24, 1.0, v24
    v_exp_f32 v27, v191
    v_add_f32 v25, 1.0, v25
    s_waitcnt lgkmcnt(4)
    v_mfma_f32_32x32x16_bf16 v[196:211], v[236:239], v[136:139], v[196:211]
    ds_read_b64_tr_b16 v[232:233], v15 offset:40960
    ds_read_b64_tr_b16 v[234:235], v15 offset:45056
    v_exp_f32 v28, v192
    v_add_f32 v26, 1.0, v26
    v_fma_f32 v24, v24, v24, 1.0
    s_waitcnt lgkmcnt(4)
    v_mfma_f32_32x32x16_bf16 v[212:227], v[240:243], v[136:139], v[212:227]
    ds_read_b64_tr_b16 v[236:237], v13 offset:43008
    ds_read_b64_tr_b16 v[238:239], v13 offset:47104
    buffer_load_dwordx4 a[204:207], v6, s[40:43], s66 offen offset:1024
    v_exp_f32 v29, v193
    v_add_f32 v27, 1.0, v27
    v_fma_f32 v25, v25, v25, 1.0
    v_exp_f32 v30, v194
    s_waitcnt lgkmcnt(4)
    v_mfma_f32_32x32x16_bf16 v[196:211], v[228:231], v[140:143], v[196:211]
    ds_read_b64_tr_b16 v[240:241], v15 offset:43008
    ds_read_b64_tr_b16 v[242:243], v15 offset:47104
    v_add_f32 v28, 1.0, v28
    v_fma_f32 v26, v26, v26, 1.0
    v_rcp_f32 v24, v24
    s_waitcnt lgkmcnt(4)
    v_mfma_f32_32x32x16_bf16 v[212:227], v[232:235], v[140:143], v[212:227]
    ds_read_b64_tr_b16 v[228:229], v13 offset:49152
    ds_read_b64_tr_b16 v[230:231], v13 offset:53248
    buffer_load_dwordx4 a[212:215], v6, s[40:43], s66 offen offset:2048
    v_exp_f32 v31, v195
    v_add_f32 v29, 1.0, v29
    v_fma_f32 v27, v27, v27, 1.0
    s_waitcnt lgkmcnt(4)
    v_mfma_f32_32x32x16_bf16 v[196:211], v[236:239], v[144:147], v[196:211]
    ds_read_b64_tr_b16 v[232:233], v15 offset:49152
    ds_read_b64_tr_b16 v[234:235], v15 offset:53248
    v_rcp_f32 v25, v25
    v_add_f32 v30, 1.0, v30
    v_fma_f32 v28, v28, v28, 1.0
    s_waitcnt lgkmcnt(4)
    v_mfma_f32_32x32x16_bf16 v[212:227], v[240:243], v[144:147], v[212:227]
    ds_read_b64_tr_b16 v[236:237], v13 offset:51200
    ds_read_b64_tr_b16 v[238:239], v13 offset:55296
    buffer_load_dwordx4 a[220:223], v6, s[40:43], s66 offen offset:3072
    v_rcp_f32 v26, v26
    v_fma_f32 v24, v24, s67, v252
    v_add_f32 v31, 1.0, v31
    v_fma_f32 v29, v29, v29, 1.0
    s_waitcnt lgkmcnt(4)
    v_mfma_f32_32x32x16_bf16 v[196:211], v[228:231], v[148:151], v[196:211]
    ds_read_b64_tr_b16 v[240:241], v15 offset:51200
    ds_read_b64_tr_b16 v[242:243], v15 offset:55296
    v_rcp_f32 v27, v27
    v_fma_f32 v25, v25, s67, v252
    v_fma_f32 v30, v30, v30, 1.0
    s_waitcnt lgkmcnt(4)
    v_mfma_f32_32x32x16_bf16 v[212:227], v[232:235], v[148:151], v[212:227]
    ds_read_b64_tr_b16 v[228:229], v13 offset:57344
    ds_read_b64_tr_b16 v[230:231], v13 offset:61440
    v_rcp_f32 v28, v28
    v_fma_f32 v26, v26, s67, v252
    v_mul_f32 v24, v188, v24
    v_fma_f32 v31, v31, v31, 1.0
    s_waitcnt lgkmcnt(4)
    v_mfma_f32_32x32x16_bf16 v[196:211], v[236:239], v[152:155], v[196:211]
    ds_read_b64_tr_b16 v[232:233], v15 offset:57344
    ds_read_b64_tr_b16 v[234:235], v15 offset:61440
    v_rcp_f32 v29, v29
    v_fma_f32 v27, v27, s67, v252
    v_mul_f32 v25, v189, v25
    s_waitcnt lgkmcnt(4)
    v_mfma_f32_32x32x16_bf16 v[212:227], v[240:243], v[152:155], v[212:227]
    ds_read_b64_tr_b16 v[236:237], v13 offset:59392
    ds_read_b64_tr_b16 v[238:239], v13 offset:63488
    v_rcp_f32 v30, v30
    v_fma_f32 v28, v28, s67, v252
    v_mul_f32 v26, v190, v26
    v_rcp_f32 v31, v31
    s_waitcnt lgkmcnt(4)
    v_mfma_f32_32x32x16_bf16 v[196:211], v[228:231], v[156:159], v[196:211]
    ds_read_b64_tr_b16 v[240:241], v15 offset:59392
    ds_read_b64_tr_b16 v[242:243], v15 offset:63488
    v_fma_f32 v29, v29, s67, v252
    v_mul_f32 v27, v191, v27
    v_fma_f32 v30, v30, s67, v252
    v_mul_f32 v28, v192, v28
    s_waitcnt lgkmcnt(4)
    v_mfma_f32_32x32x16_bf16 v[212:227], v[232:235], v[156:159], v[212:227]
    v_fma_f32 v31, v31, s67, v252
    v_mul_f32 v29, v193, v29
    v_mul_f32 v30, v194, v30
    v_mul_f32 v31, v195, v31
    s_waitcnt lgkmcnt(2)
    v_mfma_f32_32x32x16_bf16 v[196:211], v[236:239], v[160:163], v[196:211]
    v_cvt_pk_bf16_f32 v248, v24, v25
    v_cvt_pk_bf16_f32 v249, v26, v27
    v_cvt_pk_bf16_f32 v250, v28, v29
    v_cvt_pk_bf16_f32 v251, v30, v31
    buffer_store_dwordx4 v[248:251], v6, s[40:43], s5 offen offset:1024 sc1
    s_waitcnt lgkmcnt(0)
    v_mfma_f32_32x32x16_bf16 v[212:227], v[240:243], v[160:163], v[212:227]
    s_nop 4
    v_exp_f32 v36, v196
    v_exp_f32 v37, v197
    v_exp_f32 v38, v198
    v_exp_f32 v39, v199
    v_exp_f32 v40, v200
    v_exp_f32 v41, v201
    v_exp_f32 v42, v202
    v_exp_f32 v43, v203
    v_exp_f32 v44, v204
    v_exp_f32 v45, v205
    v_exp_f32 v46, v206
    v_exp_f32 v47, v207
    v_exp_f32 v48, v208
    v_exp_f32 v49, v209
    v_exp_f32 v50, v210
    v_exp_f32 v51, v211
    v_pk_add_f32 v[36:37], v[36:37], 1.0 op_sel_hi:[1,0]
    v_pk_add_f32 v[38:39], v[38:39], 1.0 op_sel_hi:[1,0]
    v_pk_add_f32 v[40:41], v[40:41], 1.0 op_sel_hi:[1,0]
    v_pk_add_f32 v[42:43], v[42:43], 1.0 op_sel_hi:[1,0]
    v_pk_add_f32 v[44:45], v[44:45], 1.0 op_sel_hi:[1,0]
    v_pk_add_f32 v[46:47], v[46:47], 1.0 op_sel_hi:[1,0]
    v_pk_add_f32 v[48:49], v[48:49], 1.0 op_sel_hi:[1,0]
    v_pk_add_f32 v[50:51], v[50:51], 1.0 op_sel_hi:[1,0]
    v_pk_fma_f32 v[36:37], v[36:37], v[36:37], 1.0 op_sel_hi:[1,1,0]
    v_pk_fma_f32 v[38:39], v[38:39], v[38:39], 1.0 op_sel_hi:[1,1,0]
    v_pk_fma_f32 v[40:41], v[40:41], v[40:41], 1.0 op_sel_hi:[1,1,0]
    v_pk_fma_f32 v[42:43], v[42:43], v[42:43], 1.0 op_sel_hi:[1,1,0]
    v_pk_fma_f32 v[44:45], v[44:45], v[44:45], 1.0 op_sel_hi:[1,1,0]
    v_pk_fma_f32 v[46:47], v[46:47], v[46:47], 1.0 op_sel_hi:[1,1,0]
    v_pk_fma_f32 v[48:49], v[48:49], v[48:49], 1.0 op_sel_hi:[1,1,0]
    v_pk_fma_f32 v[50:51], v[50:51], v[50:51], 1.0 op_sel_hi:[1,1,0]
    v_rcp_f32 v36, v36
    v_rcp_f32 v37, v37
    v_rcp_f32 v38, v38
    v_rcp_f32 v39, v39
    v_rcp_f32 v40, v40
    v_rcp_f32 v41, v41
    v_rcp_f32 v42, v42
    v_rcp_f32 v43, v43
    v_rcp_f32 v44, v44
    v_rcp_f32 v45, v45
    v_rcp_f32 v46, v46
    v_rcp_f32 v47, v47
    v_rcp_f32 v48, v48
    v_rcp_f32 v49, v49
    v_rcp_f32 v50, v50
    v_rcp_f32 v51, v51
    v_pk_fma_f32 v[36:37], v[36:37], s[66:67], v[252:253] op_sel:[0,1,0] op_sel_hi:[1,1,0]
    v_pk_fma_f32 v[38:39], v[38:39], s[66:67], v[252:253] op_sel:[0,1,0] op_sel_hi:[1,1,0]
    v_pk_fma_f32 v[40:41], v[40:41], s[66:67], v[252:253] op_sel:[0,1,0] op_sel_hi:[1,1,0]
    v_pk_fma_f32 v[42:43], v[42:43], s[66:67], v[252:253] op_sel:[0,1,0] op_sel_hi:[1,1,0]
    v_pk_fma_f32 v[44:45], v[44:45], s[66:67], v[252:253] op_sel:[0,1,0] op_sel_hi:[1,1,0]
    v_pk_fma_f32 v[46:47], v[46:47], s[66:67], v[252:253] op_sel:[0,1,0] op_sel_hi:[1,1,0]
    v_pk_fma_f32 v[48:49], v[48:49], s[66:67], v[252:253] op_sel:[0,1,0] op_sel_hi:[1,1,0]
    v_pk_fma_f32 v[50:51], v[50:51], s[66:67], v[252:253] op_sel:[0,1,0] op_sel_hi:[1,1,0]
    v_pk_mul_f32 v[36:37], v[196:197], v[36:37]
    v_pk_mul_f32 v[38:39], v[198:199], v[38:39]
    v_pk_mul_f32 v[40:41], v[200:201], v[40:41]
    v_pk_mul_f32 v[42:43], v[202:203], v[42:43]
    v_pk_mul_f32 v[44:45], v[204:205], v[44:45]
    v_pk_mul_f32 v[46:47], v[206:207], v[46:47]
    v_pk_mul_f32 v[48:49], v[208:209], v[48:49]
    v_pk_mul_f32 v[50:51], v[210:211], v[50:51]
    v_cvt_pk_bf16_f32 v68, v36, v37
    v_cvt_pk_bf16_f32 v69, v38, v39
    v_cvt_pk_bf16_f32 v70, v40, v41
    v_cvt_pk_bf16_f32 v71, v42, v43
    v_cvt_pk_bf16_f32 v72, v44, v45
    v_cvt_pk_bf16_f32 v73, v46, v47
    v_cvt_pk_bf16_f32 v74, v48, v49
    v_cvt_pk_bf16_f32 v75, v50, v51
    buffer_store_dwordx4 v[68:71], v6, s[40:43], s6 offen sc1
    buffer_store_dwordx4 v[72:75], v6, s[40:43], s6 offen offset:1024 sc1
    v_exp_f32 v52, v212
    v_exp_f32 v53, v213
    v_exp_f32 v54, v214
    v_exp_f32 v55, v215
    v_exp_f32 v56, v216
    v_exp_f32 v57, v217
    v_exp_f32 v58, v218
    v_exp_f32 v59, v219
    v_exp_f32 v60, v220
    v_exp_f32 v61, v221
    v_exp_f32 v62, v222
    v_exp_f32 v63, v223
    v_exp_f32 v64, v224
    v_exp_f32 v65, v225
    v_exp_f32 v66, v226
    v_exp_f32 v67, v227
    v_pk_add_f32 v[52:53], v[52:53], 1.0 op_sel_hi:[1,0]
    v_pk_add_f32 v[54:55], v[54:55], 1.0 op_sel_hi:[1,0]
    v_pk_add_f32 v[56:57], v[56:57], 1.0 op_sel_hi:[1,0]
    v_pk_add_f32 v[58:59], v[58:59], 1.0 op_sel_hi:[1,0]
    v_pk_add_f32 v[60:61], v[60:61], 1.0 op_sel_hi:[1,0]
    v_pk_add_f32 v[62:63], v[62:63], 1.0 op_sel_hi:[1,0]
    v_pk_add_f32 v[64:65], v[64:65], 1.0 op_sel_hi:[1,0]
    v_pk_add_f32 v[66:67], v[66:67], 1.0 op_sel_hi:[1,0]
    v_pk_fma_f32 v[52:53], v[52:53], v[52:53], 1.0 op_sel_hi:[1,1,0]
    v_pk_fma_f32 v[54:55], v[54:55], v[54:55], 1.0 op_sel_hi:[1,1,0]
    v_pk_fma_f32 v[56:57], v[56:57], v[56:57], 1.0 op_sel_hi:[1,1,0]
    v_pk_fma_f32 v[58:59], v[58:59], v[58:59], 1.0 op_sel_hi:[1,1,0]
    v_pk_fma_f32 v[60:61], v[60:61], v[60:61], 1.0 op_sel_hi:[1,1,0]
    v_pk_fma_f32 v[62:63], v[62:63], v[62:63], 1.0 op_sel_hi:[1,1,0]
    v_pk_fma_f32 v[64:65], v[64:65], v[64:65], 1.0 op_sel_hi:[1,1,0]
    v_pk_fma_f32 v[66:67], v[66:67], v[66:67], 1.0 op_sel_hi:[1,1,0]
    v_rcp_f32 v52, v52
    v_rcp_f32 v53, v53
    v_rcp_f32 v54, v54
    v_rcp_f32 v55, v55
    v_rcp_f32 v56, v56
    v_rcp_f32 v57, v57
    v_rcp_f32 v58, v58
    v_rcp_f32 v59, v59
    v_rcp_f32 v60, v60
    v_rcp_f32 v61, v61
    v_rcp_f32 v62, v62
    v_rcp_f32 v63, v63
    v_rcp_f32 v64, v64
    v_rcp_f32 v65, v65
    v_rcp_f32 v66, v66
    v_rcp_f32 v67, v67
    v_pk_fma_f32 v[52:53], v[52:53], s[66:67], v[252:253] op_sel:[0,1,0] op_sel_hi:[1,1,0]
    v_pk_fma_f32 v[54:55], v[54:55], s[66:67], v[252:253] op_sel:[0,1,0] op_sel_hi:[1,1,0]
    v_pk_fma_f32 v[56:57], v[56:57], s[66:67], v[252:253] op_sel:[0,1,0] op_sel_hi:[1,1,0]
    v_pk_fma_f32 v[58:59], v[58:59], s[66:67], v[252:253] op_sel:[0,1,0] op_sel_hi:[1,1,0]
    v_pk_fma_f32 v[60:61], v[60:61], s[66:67], v[252:253] op_sel:[0,1,0] op_sel_hi:[1,1,0]
    v_pk_fma_f32 v[62:63], v[62:63], s[66:67], v[252:253] op_sel:[0,1,0] op_sel_hi:[1,1,0]
    v_pk_fma_f32 v[64:65], v[64:65], s[66:67], v[252:253] op_sel:[0,1,0] op_sel_hi:[1,1,0]
    v_pk_fma_f32 v[66:67], v[66:67], s[66:67], v[252:253] op_sel:[0,1,0] op_sel_hi:[1,1,0]
    v_pk_mul_f32 v[52:53], v[212:213], v[52:53]
    v_pk_mul_f32 v[54:55], v[214:215], v[54:55]
    v_pk_mul_f32 v[56:57], v[216:217], v[56:57]
    v_pk_mul_f32 v[58:59], v[218:219], v[58:59]
    v_pk_mul_f32 v[60:61], v[220:221], v[60:61]
    v_pk_mul_f32 v[62:63], v[222:223], v[62:63]
    v_pk_mul_f32 v[64:65], v[224:225], v[64:65]
    v_pk_mul_f32 v[66:67], v[226:227], v[66:67]
    v_cvt_pk_bf16_f32 v76, v52, v53
    v_cvt_pk_bf16_f32 v77, v54, v55
    v_cvt_pk_bf16_f32 v78, v56, v57
    v_cvt_pk_bf16_f32 v79, v58, v59
    v_cvt_pk_bf16_f32 v80, v60, v61
    v_cvt_pk_bf16_f32 v81, v62, v63
    v_cvt_pk_bf16_f32 v82, v64, v65
    v_cvt_pk_bf16_f32 v83, v66, v67
    buffer_store_dwordx4 v[76:79], v6, s[40:43], s7 offen sc1
    buffer_store_dwordx4 v[80:83], v6, s[40:43], s7 offen offset:1024 sc1
    s_waitcnt vmcnt(0)
    s_barrier
    s_cmp_eq_u32 s16, 0
    s_cbranch_scc0 L_kB_kernel_act_pd
    s_lshl_b32 s17, s56, 7
    s_lshl_b32 s18, s57, 2
    s_add_u32 s17, s17, s18
    s_add_u32 s17, s17, 22333440
    v_mov_b32 v1, s17
    v_mov_b32 v2, 1
    s_mov_b64 exec, 1
    s_cmp_eq_u32 s58, 1
    s_cbranch_scc1 L_kB_kernel_act_pure
    buffer_wbl2 sc1
    s_waitcnt vmcnt(0)
    buffer_store_dword v2, v1, s[40:43], 0 offen sc1
    s_branch L_kB_kernel_act_pe
L_kB_kernel_act_pure:
    buffer_store_dword v2, v1, s[40:43], 0 offen
L_kB_kernel_act_pe:
    s_mov_b64 exec, -1
L_kB_kernel_act_pd:
    s_branch L_kB_kernel_k5
L_kB_kernel_skip4:
    s_add_u32 s65, s63, 8192
    buffer_load_dwordx4 a[64:67], v6, s[40:43], s65 offen offset:0
    buffer_load_dwordx4 a[72:75], v6, s[40:43], s65 offen offset:1024
    buffer_load_dwordx4 a[80:83], v6, s[40:43], s65 offen offset:2048
    buffer_load_dwordx4 a[88:91], v6, s[40:43], s65 offen offset:3072
    s_add_u32 s66, s64, 8192
    buffer_load_dwordx4 a[68:71], v6, s[40:43], s66 offen offset:0
    buffer_load_dwordx4 a[76:79], v6, s[40:43], s66 offen offset:1024
    buffer_load_dwordx4 a[84:87], v6, s[40:43], s66 offen offset:2048
    buffer_load_dwordx4 a[92:95], v6, s[40:43], s66 offen offset:3072
    s_add_u32 s65, s63, 12288
    buffer_load_dwordx4 a[96:99], v6, s[40:43], s65 offen offset:0
    buffer_load_dwordx4 a[104:107], v6, s[40:43], s65 offen offset:1024
    buffer_load_dwordx4 a[112:115], v6, s[40:43], s65 offen offset:2048
    buffer_load_dwordx4 a[120:123], v6, s[40:43], s65 offen offset:3072
    s_add_u32 s66, s64, 12288
    buffer_load_dwordx4 a[100:103], v6, s[40:43], s66 offen offset:0
    buffer_load_dwordx4 a[108:111], v6, s[40:43], s66 offen offset:1024
    buffer_load_dwordx4 a[116:119], v6, s[40:43], s66 offen offset:2048
    buffer_load_dwordx4 a[124:127], v6, s[40:43], s66 offen offset:3072
    s_add_u32 s65, s63, 16384
    buffer_load_dwordx4 a[128:131], v6, s[40:43], s65 offen offset:0
    buffer_load_dwordx4 a[136:139], v6, s[40:43], s65 offen offset:1024
    buffer_load_dwordx4 a[144:147], v6, s[40:43], s65 offen offset:2048
    buffer_load_dwordx4 a[152:155], v6, s[40:43], s65 offen offset:3072
    s_add_u32 s66, s64, 16384
    buffer_load_dwordx4 a[132:135], v6, s[40:43], s66 offen offset:0
    buffer_load_dwordx4 a[140:143], v6, s[40:43], s66 offen offset:1024
    buffer_load_dwordx4 a[148:151], v6, s[40:43], s66 offen offset:2048
    buffer_load_dwordx4 a[156:159], v6, s[40:43], s66 offen offset:3072
    s_add_u32 s65, s63, 20480
    buffer_load_dwordx4 a[160:163], v6, s[40:43], s65 offen offset:0
    buffer_load_dwordx4 a[168:171], v6, s[40:43], s65 offen offset:1024
    buffer_load_dwordx4 a[176:179], v6, s[40:43], s65 offen offset:2048
    buffer_load_dwordx4 a[184:187], v6, s[40:43], s65 offen offset:3072
    s_add_u32 s66, s64, 20480
    buffer_load_dwordx4 a[164:167], v6, s[40:43], s66 offen offset:0
    buffer_load_dwordx4 a[172:175], v6, s[40:43], s66 offen offset:1024
    buffer_load_dwordx4 a[180:183], v6, s[40:43], s66 offen offset:2048
    buffer_load_dwordx4 a[188:191], v6, s[40:43], s66 offen offset:3072
    s_add_u32 s65, s63, 24576
    buffer_load_dwordx4 a[192:195], v6, s[40:43], s65 offen offset:0
    buffer_load_dwordx4 a[200:203], v6, s[40:43], s65 offen offset:1024
    buffer_load_dwordx4 a[208:211], v6, s[40:43], s65 offen offset:2048
    buffer_load_dwordx4 a[216:219], v6, s[40:43], s65 offen offset:3072
    s_add_u32 s66, s64, 24576
    buffer_load_dwordx4 a[196:199], v6, s[40:43], s66 offen offset:0
    buffer_load_dwordx4 a[204:207], v6, s[40:43], s66 offen offset:1024
    buffer_load_dwordx4 a[212:215], v6, s[40:43], s66 offen offset:2048
    buffer_load_dwordx4 a[220:223], v6, s[40:43], s66 offen offset:3072
L_kB_kernel_k5:
    s_lshr_b32 s17, s57, 3
    s_and_b32 s18, s57, 7
    s_lshl_b32 s19, s56, 3
    s_lshl_b32 s20, s17, 1
    s_add_u32 s19, s19, s20
    s_mul_i32 s20, s19, 123904
    s_mul_i32 s21, s16, 30720
    s_add_u32 s20, s20, s21
    s_add_u32 s20, s20, 10584064
    s_lshr_b32 s24, s16, 1
    s_mul_i32 s25, s24, 123904
    s_xor_b32 s24, s24, 1
    s_mul_i32 s24, s24, 123904
    s_add_u32 s21, s20, s24
    s_add_u32 s20, s20, s25
    v_and_b32 v7, 31, v3
    v_lshlrev_b32 v11, 10, v7
    v_lshrrev_b32 v8, 5, v3
    v_lshl_add_u32 v11, v8, 4, v11
    s_lshr_b32 s24, s16, 1
    s_add_u32 s23, s19, s24
    s_lshl_b32 s23, s23, 15
    s_lshl_b32 s24, s18, 1
    s_and_b32 s25, s16, 1
    s_add_u32 s24, s24, s25
    s_lshl_b32 s25, s24, 11
    s_add_u32 s25, s25, s23
    s_add_u32 s25, s25, 8486912
    s_lshl_b32 s24, s24, 6
    s_add_u32 s23, s23, s24
    v_min_u32 v12, 13, v3
    s_lshr_b32 s17, s17, 1
    s_mul_i32 s17, s17, 56
    s_lshl_b32 s18, s56, 7
    s_add_u32 s17, s17, s18
    s_add_u32 s17, s17, 22333440
    v_lshlrev_b32 v12, 2, v12
    v_add_u32 v12, s17, v12
    s_cmp_eq_u32 s16, 0
    s_cbranch_scc0 L_kB_kernel_actw_done
    s_mov_b32 s17, 0
L_kB_kernel_actw_poll:
    buffer_load_dword v1, v12, s[40:43], 0 offen sc1
    s_waitcnt vmcnt(0)
    v_cmp_ne_u32 vcc, 1, v1
    s_nop 4
    s_cbranch_vccz L_kB_kernel_actw_ok
    s_add_u32 s17, s17, 1
    s_cmp_lt_u32 s17, 400000
    s_cbranch_scc1 L_kB_kernel_actw_poll
L_kB_kernel_actw_ok:
    s_cmp_eq_u32 s58, 1
    s_cbranch_scc1 L_kB_kernel_actw_done
    buffer_inv sc1
    s_waitcnt vmcnt(0)
L_kB_kernel_actw_done:
    s_barrier
    s_add_u32 s26, s20, 0
    buffer_load_dwordx4 v[16:19], v6, s[40:43], s26 offen offset:0
    s_add_u32 s27, s21, 0
    buffer_load_dwordx4 v[20:23], v6, s[40:43], s27 offen offset:0
    buffer_load_dwordx4 v[24:27], v6, s[40:43], s26 offen offset:1024
    buffer_load_dwordx4 v[28:31], v6, s[40:43], s27 offen offset:1024
    buffer_load_dwordx4 v[32:35], v6, s[40:43], s26 offen offset:2048
    buffer_load_dwordx4 v[36:39], v6, s[40:43], s27 offen offset:2048
    buffer_load_dwordx4 v[40:43], v6, s[40:43], s26 offen offset:3072
    buffer_load_dwordx4 v[44:47], v6, s[40:43], s27 offen offset:3072
    s_add_u32 s26, s20, 4096
    buffer_load_dwordx4 v[48:51], v6, s[40:43], s26 offen offset:0
    s_add_u32 s27, s21, 4096
    buffer_load_dwordx4 v[52:55], v6, s[40:43], s27 offen offset:0
    buffer_load_dwordx4 v[56:59], v6, s[40:43], s26 offen offset:1024
    buffer_load_dwordx4 v[60:63], v6, s[40:43], s27 offen offset:1024
    buffer_load_dwordx4 v[64:67], v6, s[40:43], s26 offen offset:2048
    buffer_load_dwordx4 v[68:71], v6, s[40:43], s27 offen offset:2048
    s_waitcnt vmcnt(12)
    v_mfma_f32_32x32x16_bf16 v[80:95], a[0:3], v[16:19], 0
    v_mfma_f32_32x32x16_bf16 v[112:127], a[4:7], v[16:19], 0
    v_mfma_f32_32x32x16_bf16 v[96:111], a[0:3], v[20:23], 0
    v_mfma_f32_32x32x16_bf16 v[128:143], a[4:7], v[20:23], 0
    s_waitcnt vmcnt(10)
    v_mfma_f32_32x32x16_bf16 v[80:95], a[8:11], v[24:27], v[80:95]
    buffer_load_dwordx4 v[16:19], v6, s[40:43], s26 offen offset:3072
    v_mfma_f32_32x32x16_bf16 v[112:127], a[12:15], v[24:27], v[112:127]
    v_mfma_f32_32x32x16_bf16 v[96:111], a[8:11], v[28:31], v[96:111]
    buffer_load_dwordx4 v[20:23], v6, s[40:43], s27 offen offset:3072
    v_mfma_f32_32x32x16_bf16 v[128:143], a[12:15], v[28:31], v[128:143]
    s_waitcnt vmcnt(10)
    v_mfma_f32_32x32x16_bf16 v[80:95], a[16:19], v[32:35], v[80:95]
    s_add_u32 s26, s20, 8192
    buffer_load_dwordx4 v[24:27], v6, s[40:43], s26 offen offset:0
    v_mfma_f32_32x32x16_bf16 v[112:127], a[20:23], v[32:35], v[112:127]
    v_mfma_f32_32x32x16_bf16 v[96:111], a[16:19], v[36:39], v[96:111]
    s_add_u32 s27, s21, 8192
    buffer_load_dwordx4 v[28:31], v6, s[40:43], s27 offen offset:0
    v_mfma_f32_32x32x16_bf16 v[128:143], a[20:23], v[36:39], v[128:143]
    s_waitcnt vmcnt(10)
    v_mfma_f32_32x32x16_bf16 v[80:95], a[24:27], v[40:43], v[80:95]
    buffer_load_dwordx4 v[32:35], v6, s[40:43], s26 offen offset:1024
    v_mfma_f32_32x32x16_bf16 v[112:127], a[28:31], v[40:43], v[112:127]
    v_mfma_f32_32x32x16_bf16 v[96:111], a[24:27], v[44:47], v[96:111]
    buffer_load_dwordx4 v[36:39], v6, s[40:43], s27 offen offset:1024
    v_mfma_f32_32x32x16_bf16 v[128:143], a[28:31], v[44:47], v[128:143]
    s_waitcnt vmcnt(10)
    v_mfma_f32_32x32x16_bf16 v[80:95], a[32:35], v[48:51], v[80:95]
    buffer_load_dwordx4 v[40:43], v6, s[40:43], s26 offen offset:2048
    v_mfma_f32_32x32x16_bf16 v[112:127], a[36:39], v[48:51], v[112:127]
    v_mfma_f32_32x32x16_bf16 v[96:111], a[32:35], v[52:55], v[96:111]
    buffer_load_dwordx4 v[44:47], v6, s[40:43], s27 offen offset:2048
    v_mfma_f32_32x32x16_bf16 v[128:143], a[36:39], v[52:55], v[128:143]
    s_waitcnt vmcnt(10)
    v_mfma_f32_32x32x16_bf16 v[80:95], a[40:43], v[56:59], v[80:95]
    buffer_load_dwordx4 v[48:51], v6, s[40:43], s26 offen offset:3072
    v_mfma_f32_32x32x16_bf16 v[112:127], a[44:47], v[56:59], v[112:127]
    v_mfma_f32_32x32x16_bf16 v[96:111], a[40:43], v[60:63], v[96:111]
    buffer_load_dwordx4 v[52:55], v6, s[40:43], s27 offen offset:3072
    v_mfma_f32_32x32x16_bf16 v[128:143], a[44:47], v[60:63], v[128:143]
    s_waitcnt vmcnt(10)
    v_mfma_f32_32x32x16_bf16 v[80:95], a[48:51], v[64:67], v[80:95]
    s_add_u32 s26, s20, 12288
    buffer_load_dwordx4 v[56:59], v6, s[40:43], s26 offen offset:0
    v_mfma_f32_32x32x16_bf16 v[112:127], a[52:55], v[64:67], v[112:127]
    v_mfma_f32_32x32x16_bf16 v[96:111], a[48:51], v[68:71], v[96:111]
    s_add_u32 s27, s21, 12288
    buffer_load_dwordx4 v[60:63], v6, s[40:43], s27 offen offset:0
    v_mfma_f32_32x32x16_bf16 v[128:143], a[52:55], v[68:71], v[128:143]
    s_waitcnt vmcnt(10)
    v_mfma_f32_32x32x16_bf16 v[80:95], a[56:59], v[16:19], v[80:95]
    buffer_load_dwordx4 v[64:67], v6, s[40:43], s26 offen offset:1024
    v_mfma_f32_32x32x16_bf16 v[112:127], a[60:63], v[16:19], v[112:127]
    v_mfma_f32_32x32x16_bf16 v[96:111], a[56:59], v[20:23], v[96:111]
    buffer_load_dwordx4 v[68:71], v6, s[40:43], s27 offen offset:1024
    v_mfma_f32_32x32x16_bf16 v[128:143], a[60:63], v[20:23], v[128:143]
    s_waitcnt vmcnt(10)
    v_mfma_f32_32x32x16_bf16 v[80:95], a[64:67], v[24:27], v[80:95]
    buffer_load_dwordx4 v[16:19], v6, s[40:43], s26 offen offset:2048
    v_mfma_f32_32x32x16_bf16 v[112:127], a[68:71], v[24:27], v[112:127]
    v_mfma_f32_32x32x16_bf16 v[96:111], a[64:67], v[28:31], v[96:111]
    buffer_load_dwordx4 v[20:23], v6, s[40:43], s27 offen offset:2048
    v_mfma_f32_32x32x16_bf16 v[128:143], a[68:71], v[28:31], v[128:143]
    s_waitcnt vmcnt(10)
    v_mfma_f32_32x32x16_bf16 v[80:95], a[72:75], v[32:35], v[80:95]
    buffer_load_dwordx4 v[24:27], v6, s[40:43], s26 offen offset:3072
    v_mfma_f32_32x32x16_bf16 v[112:127], a[76:79], v[32:35], v[112:127]
    v_mfma_f32_32x32x16_bf16 v[96:111], a[72:75], v[36:39], v[96:111]
    buffer_load_dwordx4 v[28:31], v6, s[40:43], s27 offen offset:3072
    v_mfma_f32_32x32x16_bf16 v[128:143], a[76:79], v[36:39], v[128:143]
    s_waitcnt vmcnt(10)
    v_mfma_f32_32x32x16_bf16 v[80:95], a[80:83], v[40:43], v[80:95]
    s_add_u32 s26, s20, 16384
    buffer_load_dwordx4 v[32:35], v6, s[40:43], s26 offen offset:0
    v_mfma_f32_32x32x16_bf16 v[112:127], a[84:87], v[40:43], v[112:127]
    v_mfma_f32_32x32x16_bf16 v[96:111], a[80:83], v[44:47], v[96:111]
    s_add_u32 s27, s21, 16384
    buffer_load_dwordx4 v[36:39], v6, s[40:43], s27 offen offset:0
    v_mfma_f32_32x32x16_bf16 v[128:143], a[84:87], v[44:47], v[128:143]
    s_waitcnt vmcnt(10)
    v_mfma_f32_32x32x16_bf16 v[80:95], a[88:91], v[48:51], v[80:95]
    buffer_load_dwordx4 v[40:43], v6, s[40:43], s26 offen offset:1024
    v_mfma_f32_32x32x16_bf16 v[112:127], a[92:95], v[48:51], v[112:127]
    v_mfma_f32_32x32x16_bf16 v[96:111], a[88:91], v[52:55], v[96:111]
    buffer_load_dwordx4 v[44:47], v6, s[40:43], s27 offen offset:1024
    v_mfma_f32_32x32x16_bf16 v[128:143], a[92:95], v[52:55], v[128:143]
    s_waitcnt vmcnt(10)
    v_mfma_f32_32x32x16_bf16 v[80:95], a[96:99], v[56:59], v[80:95]
    buffer_load_dwordx4 v[48:51], v6, s[40:43], s26 offen offset:2048
    v_mfma_f32_32x32x16_bf16 v[112:127], a[100:103], v[56:59], v[112:127]
    v_mfma_f32_32x32x16_bf16 v[96:111], a[96:99], v[60:63], v[96:111]
    buffer_load_dwordx4 v[52:55], v6, s[40:43], s27 offen offset:2048
    v_mfma_f32_32x32x16_bf16 v[128:143], a[100:103], v[60:63], v[128:143]
    s_waitcnt vmcnt(10)
    v_mfma_f32_32x32x16_bf16 v[80:95], a[104:107], v[64:67], v[80:95]
    buffer_load_dwordx4 v[56:59], v6, s[40:43], s26 offen offset:3072
    v_mfma_f32_32x32x16_bf16 v[112:127], a[108:111], v[64:67], v[112:127]
    v_mfma_f32_32x32x16_bf16 v[96:111], a[104:107], v[68:71], v[96:111]
    buffer_load_dwordx4 v[60:63], v6, s[40:43], s27 offen offset:3072
    v_mfma_f32_32x32x16_bf16 v[128:143], a[108:111], v[68:71], v[128:143]
    s_waitcnt vmcnt(10)
    v_mfma_f32_32x32x16_bf16 v[80:95], a[112:115], v[16:19], v[80:95]
    s_add_u32 s26, s20, 20480
    buffer_load_dwordx4 v[64:67], v6, s[40:43], s26 offen offset:0
    v_mfma_f32_32x32x16_bf16 v[112:127], a[116:119], v[16:19], v[112:127]
    v_mfma_f32_32x32x16_bf16 v[96:111], a[112:115], v[20:23], v[96:111]
    s_add_u32 s27, s21, 20480
    buffer_load_dwordx4 v[68:71], v6, s[40:43], s27 offen offset:0
    v_mfma_f32_32x32x16_bf16 v[128:143], a[116:119], v[20:23], v[128:143]
    s_waitcnt vmcnt(10)
    v_mfma_f32_32x32x16_bf16 v[80:95], a[120:123], v[24:27], v[80:95]
    buffer_load_dwordx4 v[16:19], v6, s[40:43], s26 offen offset:1024
    v_mfma_f32_32x32x16_bf16 v[112:127], a[124:127], v[24:27], v[112:127]
    v_mfma_f32_32x32x16_bf16 v[96:111], a[120:123], v[28:31], v[96:111]
    buffer_load_dwordx4 v[20:23], v6, s[40:43], s27 offen offset:1024
    v_mfma_f32_32x32x16_bf16 v[128:143], a[124:127], v[28:31], v[128:143]
    s_waitcnt vmcnt(10)
    v_mfma_f32_32x32x16_bf16 v[80:95], a[128:131], v[32:35], v[80:95]
    buffer_load_dwordx4 v[24:27], v6, s[40:43], s26 offen offset:2048
    v_mfma_f32_32x32x16_bf16 v[112:127], a[132:135], v[32:35], v[112:127]
    v_mfma_f32_32x32x16_bf16 v[96:111], a[128:131], v[36:39], v[96:111]
    buffer_load_dwordx4 v[28:31], v6, s[40:43], s27 offen offset:2048
    v_mfma_f32_32x32x16_bf16 v[128:143], a[132:135], v[36:39], v[128:143]
    s_waitcnt vmcnt(10)
    v_mfma_f32_32x32x16_bf16 v[80:95], a[136:139], v[40:43], v[80:95]
    buffer_load_dwordx4 v[32:35], v6, s[40:43], s26 offen offset:3072
    v_mfma_f32_32x32x16_bf16 v[112:127], a[140:143], v[40:43], v[112:127]
    v_mfma_f32_32x32x16_bf16 v[96:111], a[136:139], v[44:47], v[96:111]
    buffer_load_dwordx4 v[36:39], v6, s[40:43], s27 offen offset:3072
    v_mfma_f32_32x32x16_bf16 v[128:143], a[140:143], v[44:47], v[128:143]
    s_waitcnt vmcnt(10)
    v_mfma_f32_32x32x16_bf16 v[80:95], a[144:147], v[48:51], v[80:95]
    s_add_u32 s26, s20, 24576
    buffer_load_dwordx4 v[40:43], v6, s[40:43], s26 offen offset:0
    v_mfma_f32_32x32x16_bf16 v[112:127], a[148:151], v[48:51], v[112:127]
    v_mfma_f32_32x32x16_bf16 v[96:111], a[144:147], v[52:55], v[96:111]
    s_add_u32 s27, s21, 24576
    buffer_load_dwordx4 v[44:47], v6, s[40:43], s27 offen offset:0
    v_mfma_f32_32x32x16_bf16 v[128:143], a[148:151], v[52:55], v[128:143]
    s_waitcnt vmcnt(10)
    v_mfma_f32_32x32x16_bf16 v[80:95], a[152:155], v[56:59], v[80:95]
    buffer_load_dwordx4 v[48:51], v6, s[40:43], s26 offen offset:1024
    v_mfma_f32_32x32x16_bf16 v[112:127], a[156:159], v[56:59], v[112:127]
    v_mfma_f32_32x32x16_bf16 v[96:111], a[152:155], v[60:63], v[96:111]
    buffer_load_dwordx4 v[52:55], v6, s[40:43], s27 offen offset:1024
    v_mfma_f32_32x32x16_bf16 v[128:143], a[156:159], v[60:63], v[128:143]
    s_waitcnt vmcnt(10)
    v_mfma_f32_32x32x16_bf16 v[80:95], a[160:163], v[64:67], v[80:95]
    buffer_load_dwordx4 v[56:59], v6, s[40:43], s26 offen offset:2048
    v_mfma_f32_32x32x16_bf16 v[112:127], a[164:167], v[64:67], v[112:127]
    v_mfma_f32_32x32x16_bf16 v[96:111], a[160:163], v[68:71], v[96:111]
    buffer_load_dwordx4 v[60:63], v6, s[40:43], s27 offen offset:2048
    v_mfma_f32_32x32x16_bf16 v[128:143], a[164:167], v[68:71], v[128:143]
    s_waitcnt vmcnt(10)
    v_mfma_f32_32x32x16_bf16 v[80:95], a[168:171], v[16:19], v[80:95]
    buffer_load_dwordx4 v[64:67], v6, s[40:43], s26 offen offset:3072
    v_mfma_f32_32x32x16_bf16 v[112:127], a[172:175], v[16:19], v[112:127]
    v_mfma_f32_32x32x16_bf16 v[96:111], a[168:171], v[20:23], v[96:111]
    buffer_load_dwordx4 v[68:71], v6, s[40:43], s27 offen offset:3072
    v_mfma_f32_32x32x16_bf16 v[128:143], a[172:175], v[20:23], v[128:143]
    s_waitcnt vmcnt(10)
    v_mfma_f32_32x32x16_bf16 v[80:95], a[176:179], v[24:27], v[80:95]
    v_mfma_f32_32x32x16_bf16 v[112:127], a[180:183], v[24:27], v[112:127]
    v_mfma_f32_32x32x16_bf16 v[96:111], a[176:179], v[28:31], v[96:111]
    v_mfma_f32_32x32x16_bf16 v[128:143], a[180:183], v[28:31], v[128:143]
    s_waitcnt vmcnt(8)
    v_mfma_f32_32x32x16_bf16 v[80:95], a[184:187], v[32:35], v[80:95]
    v_mfma_f32_32x32x16_bf16 v[112:127], a[188:191], v[32:35], v[112:127]
    v_mfma_f32_32x32x16_bf16 v[96:111], a[184:187], v[36:39], v[96:111]
    v_mfma_f32_32x32x16_bf16 v[128:143], a[188:191], v[36:39], v[128:143]
    s_waitcnt vmcnt(6)
    v_mfma_f32_32x32x16_bf16 v[80:95], a[192:195], v[40:43], v[80:95]
    v_mfma_f32_32x32x16_bf16 v[112:127], a[196:199], v[40:43], v[112:127]
    v_mfma_f32_32x32x16_bf16 v[96:111], a[192:195], v[44:47], v[96:111]
    v_mfma_f32_32x32x16_bf16 v[128:143], a[196:199], v[44:47], v[128:143]
    s_waitcnt vmcnt(4)
    v_mfma_f32_32x32x16_bf16 v[80:95], a[200:203], v[48:51], v[80:95]
    v_mfma_f32_32x32x16_bf16 v[112:127], a[204:207], v[48:51], v[112:127]
    v_mfma_f32_32x32x16_bf16 v[96:111], a[200:203], v[52:55], v[96:111]
    v_mfma_f32_32x32x16_bf16 v[128:143], a[204:207], v[52:55], v[128:143]
    s_waitcnt vmcnt(2)
    v_mfma_f32_32x32x16_bf16 v[80:95], a[208:211], v[56:59], v[80:95]
    buffer_load_dwordx4 v[72:75], v6, s[40:43], s25 offen offset:0
    v_mfma_f32_32x32x16_bf16 v[112:127], a[212:215], v[56:59], v[112:127]
    v_mfma_f32_32x32x16_bf16 v[96:111], a[208:211], v[60:63], v[96:111]
    buffer_load_dwordx4 v[76:79], v6, s[40:43], s25 offen offset:1024
    v_mfma_f32_32x32x16_bf16 v[128:143], a[212:215], v[60:63], v[128:143]
    s_waitcnt vmcnt(2)
    v_mfma_f32_32x32x16_bf16 v[80:95], a[216:219], v[64:67], v[80:95]
    v_mfma_f32_32x32x16_bf16 v[112:127], a[220:223], v[64:67], v[112:127]
    v_mfma_f32_32x32x16_bf16 v[96:111], a[216:219], v[68:71], v[96:111]
    v_mfma_f32_32x32x16_bf16 v[128:143], a[220:223], v[68:71], v[128:143]
    s_xor_b32 s28, s16, 1
    s_mul_i32 s28, s28, 12288
    s_add_u32 s28, s28, 0
    v_add_u32 v144, s28, v6
    s_xor_b32 s28, s16, 2
    s_mul_i32 s28, s28, 12288
    s_add_u32 s28, s28, 4096
    v_add_u32 v145, s28, v6
    s_xor_b32 s28, s16, 3
    s_mul_i32 s28, s28, 12288
    s_add_u32 s28, s28, 8192
    v_add_u32 v146, s28, v6
    ds_write_b128 v144, v[112:115] offset:0
    ds_write_b128 v144, v[116:119] offset:1024
    ds_write_b128 v144, v[120:123] offset:2048
    ds_write_b128 v144, v[124:127] offset:3072
    ds_write_b128 v145, v[96:99] offset:0
    ds_write_b128 v145, v[100:103] offset:1024
    ds_write_b128 v145, v[104:107] offset:2048
    ds_write_b128 v145, v[108:111] offset:3072
    ds_write_b128 v146, v[128:131] offset:0
    ds_write_b128 v146, v[132:135] offset:1024
    ds_write_b128 v146, v[136:139] offset:2048
    ds_write_b128 v146, v[140:143] offset:3072
    s_mul_i32 s28, s16, 12288
    v_add_u32 v147, s28, v6
    s_waitcnt vmcnt(0)
    v_lshlrev_b32 v16, 16, v72
    v_and_b32 v17, 0xffff0000, v72
    v_lshlrev_b32 v18, 16, v73
    v_and_b32 v19, 0xffff0000, v73
    v_lshlrev_b32 v20, 16, v76
    v_and_b32 v21, 0xffff0000, v76
    v_lshlrev_b32 v22, 16, v77
    v_and_b32 v23, 0xffff0000, v77
    v_lshlrev_b32 v24, 16, v74
    v_and_b32 v25, 0xffff0000, v74
    v_lshlrev_b32 v26, 16, v75
    v_and_b32 v27, 0xffff0000, v75
    v_lshlrev_b32 v28, 16, v78
    v_and_b32 v29, 0xffff0000, v78
    v_lshlrev_b32 v30, 16, v79
    v_and_b32 v31, 0xffff0000, v79
    v_pk_add_f32 v[80:81], v[80:81], v[16:17]
    v_pk_add_f32 v[82:83], v[82:83], v[18:19]
    v_pk_add_f32 v[84:85], v[84:85], v[20:21]
    v_pk_add_f32 v[86:87], v[86:87], v[22:23]
    v_pk_add_f32 v[88:89], v[88:89], v[24:25]
    v_pk_add_f32 v[90:91], v[90:91], v[26:27]
    v_pk_add_f32 v[92:93], v[92:93], v[28:29]
    v_pk_add_f32 v[94:95], v[94:95], v[30:31]
    s_waitcnt lgkmcnt(0)
    s_barrier
    ds_read_b128 v[148:151], v147 offset:0
    ds_read_b128 v[152:155], v147 offset:1024
    ds_read_b128 v[156:159], v147 offset:2048
    ds_read_b128 v[160:163], v147 offset:3072
    ds_read_b128 v[164:167], v147 offset:4096
    ds_read_b128 v[168:171], v147 offset:5120
    ds_read_b128 v[172:175], v147 offset:6144
    ds_read_b128 v[176:179], v147 offset:7168
    ds_read_b128 v[180:183], v147 offset:8192
    ds_read_b128 v[184:187], v147 offset:9216
    ds_read_b128 v[188:191], v147 offset:10240
    ds_read_b128 v[192:195], v147 offset:11264
    s_waitcnt lgkmcnt(8)
    v_pk_add_f32 v[80:81], v[80:81], v[148:149]
    v_pk_add_f32 v[82:83], v[82:83], v[150:151]
    v_pk_add_f32 v[84:85], v[84:85], v[152:153]
    v_pk_add_f32 v[86:87], v[86:87], v[154:155]
    v_pk_add_f32 v[88:89], v[88:89], v[156:157]
    v_pk_add_f32 v[90:91], v[90:91], v[158:159]
    v_pk_add_f32 v[92:93], v[92:93], v[160:161]
    v_pk_add_f32 v[94:95], v[94:95], v[162:163]
    s_waitcnt lgkmcnt(4)
    v_pk_add_f32 v[80:81], v[80:81], v[164:165]
    v_pk_add_f32 v[82:83], v[82:83], v[166:167]
    v_pk_add_f32 v[84:85], v[84:85], v[168:169]
    v_pk_add_f32 v[86:87], v[86:87], v[170:171]
    v_pk_add_f32 v[88:89], v[88:89], v[172:173]
    v_pk_add_f32 v[90:91], v[90:91], v[174:175]
    v_pk_add_f32 v[92:93], v[92:93], v[176:177]
    v_pk_add_f32 v[94:95], v[94:95], v[178:179]
    s_waitcnt lgkmcnt(0)
    v_pk_add_f32 v[80:81], v[80:81], v[180:181]
    v_pk_add_f32 v[82:83], v[82:83], v[182:183]
    v_pk_add_f32 v[84:85], v[84:85], v[184:185]
    v_pk_add_f32 v[86:87], v[86:87], v[186:187]
    v_pk_add_f32 v[88:89], v[88:89], v[188:189]
    v_pk_add_f32 v[90:91], v[90:91], v[190:191]
    v_pk_add_f32 v[92:93], v[92:93], v[192:193]
    v_pk_add_f32 v[94:95], v[94:95], v[194:195]
    v_cvt_pk_bf16_f32 v112, v80, v81
    v_cvt_pk_bf16_f32 v113, v82, v83
    v_cvt_pk_bf16_f32 v114, v84, v85
    v_cvt_pk_bf16_f32 v115, v86, v87
    v_cvt_pk_bf16_f32 v116, v88, v89
    v_cvt_pk_bf16_f32 v117, v90, v91
    v_cvt_pk_bf16_f32 v118, v92, v93
    v_cvt_pk_bf16_f32 v119, v94, v95
    v_permlane32_swap_b32 v112, v114
    v_permlane32_swap_b32 v113, v115
    v_permlane32_swap_b32 v116, v118
    v_permlane32_swap_b32 v117, v119
    buffer_store_dwordx4 v[112:115], v11, s[52:55], s23 offen
    buffer_store_dwordx4 v[116:119], v11, s[52:55], s23 offen offset:32
L_kB_kernel_end:
    s_endpgm
L_code_end:
.section .rodata,"a"
.p2align 6
.amdhsa_kernel kB_kernel
  .amdhsa_next_free_vgpr 512
  .amdhsa_next_free_sgpr 102
  .amdhsa_accum_offset 256
  .amdhsa_group_segment_fixed_size 0
  .amdhsa_kernarg_size 80
  .amdhsa_user_sgpr_count 2
  .amdhsa_user_sgpr_kernarg_segment_ptr 1
  .amdhsa_system_sgpr_workgroup_id_x 1
  .amdhsa_float_denorm_mode_32 3
  .amdhsa_float_denorm_mode_16_64 3
.end_amdhsa_kernel
.text
```
